```python
import torch

def _softmax(x, axis=-1):
    return torch.softmax(x, dim=axis)

def _gelu(x):
    return torch.nn.functional.gelu(x, approximate='tanh')

def _silu(x):
    return torch.nn.functional.silu(x)

def _sigmoid(x):
    return torch.sigmoid(x)

def _layernorm(x, axis=-1, eps=1e-05):
    m = x.mean(dim=axis, keepdim=True)
    v = x.var(dim=axis, keepdim=True, unbiased=False)
    return (x - m) / torch.sqrt(v + eps)

def _scatter_add(tgt, idx, src, axis=0):
    return tgt.clone().index_add_(axis, idx, src)

def _segment_sum(src, seg, n):
    out = torch.zeros((n,) + src.shape[1:], dtype=src.dtype)
    return out.index_add_(0, seg, src)

def _pad(x, pw):
    flat = tuple((v for pair in reversed(pw) for v in pair))
    return torch.nn.functional.pad(x, flat)
kernel_name = 'recurrent_scan__memory_aug_recurrent_mem_tr__mixer_channel_mlp__prompt'

def setup_inputs():

    _w = lambda a: (lambda t: t.to(torch.bfloat16) if t.is_floating_point() else t)(torch.as_tensor(a))

    def _A_setup():
        B, S, Dm = (1, 2048, 512)
        H, Dh = (32, 128)
        M, seg = (8, 32)
        seg = min(seg, S)
        S = S // seg * seg
        return {'x': _w((lambda *s: torch.randn(*s, dtype=torch.bfloat16) * 0.05)(B, S, Dm)), 'mem0': _w((lambda *s: torch.randn(*s, dtype=torch.bfloat16) * 0.8)(B, M, Dm)), 'Wq': _w((lambda *s: torch.randn(*s, dtype=torch.bfloat16) * 0.8)(Dm, H, Dh) * Dm ** (-0.5)), 'Wk': _w((lambda *s: torch.randn(*s, dtype=torch.bfloat16) * 0.8)(Dm, H, Dh) * Dm ** (-0.5)), 'Wv': _w((lambda *s: torch.randn(*s, dtype=torch.bfloat16) * 0.8)(Dm, H, Dh) * Dm ** (-0.5)), 'Wo': _w((lambda *s: torch.randn(*s, dtype=torch.bfloat16) * 0.8)(H, Dh, Dm) * (H * Dh) ** (-0.5)), 'seg_len': seg}
    _A_in = _A_setup()

    def _B_setup():
        B, S, D, F = (1, 2048, 512, 1376)
        return {'x': _w((lambda *s: torch.randn(*s, dtype=torch.bfloat16) * 0.05)(B, S, D)), 'w1': _w((lambda *s: torch.randn(*s, dtype=torch.bfloat16) * 0.8)(D, F) * D ** (-0.5)), 'b1': _w((lambda *s: torch.randn(*s, dtype=torch.bfloat16) * 0.4)(F)), 'w2': _w((lambda *s: torch.randn(*s, dtype=torch.bfloat16) * 0.2)(F, D) * F ** (-0.5)), 'b2': _w((lambda *s: torch.randn(*s, dtype=torch.bfloat16) * 0.2)(D))}
    _B_in = _B_setup()
    return {'A_x': _A_in['x'], 'A_mem0': _A_in['mem0'], 'A_Wq': _A_in['Wq'], 'A_Wk': _A_in['Wk'], 'A_Wv': _A_in['Wv'], 'A_Wo': _A_in['Wo'], 'A_seg_len': _A_in['seg_len'], 'B_x': _B_in['x'], 'B_w1': _B_in['w1'], 'B_b1': _B_in['b1'], 'B_w2': _B_in['w2'], 'B_b2': _B_in['b2']}

def reference(A_x, A_mem0, A_Wq, A_Wk, A_Wv, A_Wo, A_seg_len, B_x, B_w1, B_b1, B_w2, B_b2):

    def _A_ref(x, mem0, Wq, Wk, Wv, Wo, seg_len):
        B, S, Dm = x.shape
        H, Dh = (Wq.shape[1], Wq.shape[2])
        M = mem0.shape[1]
        scale = Dh ** (-0.5)
        n_seg = S // seg_len
        L = M + seg_len
        idx = torch.arange(L)
        mask = (idx[:, None] < M) | (idx[:, None] >= idx[None, :])
        mem = mem0
        outs = []
        for s in range(n_seg):
            xs = x[:, s * seg_len:(s + 1) * seg_len, :].clone()
            h = torch.concatenate([mem, xs], axis=1)
            q = torch.einsum('btd,dhe->bhte', h, Wq)
            k = torch.einsum('btd,dhe->bhte', h, Wk)
            v = torch.einsum('btd,dhe->bhte', h, Wv)
            scores = torch.einsum('bhqe,bhke->bhqk', q, k) * scale
            scores = torch.where(mask[None, None], scores, -1000000000.0)
            p = _softmax(scores, axis=-1)
            o = torch.einsum('bhqk,bhke->bhqe', p, v)
            o = torch.einsum('bhte,hed->btd', o, Wo)
            mem = o[:, :M, :].clone()
            outs.append(o[:, M:, :])
        return torch.concatenate(outs, axis=1)

    def _B_ref(x, w1, b1, w2, b2):
        y = _layernorm(x, axis=-1)
        h = _gelu(torch.einsum('bsd,df->bsf', y, w1) + b1)
        return torch.einsum('bsf,fd->bsd', h, w2) + b2
    x = A_x
    xn = _layernorm(x, axis=-1)
    s = _A_ref(xn, A_mem0, A_Wq, A_Wk, A_Wv, A_Wo, A_seg_len)
    g = _silu(_B_ref(xn, B_w1, B_b1, B_w2, B_b2))
    return x + s * g
```

```asm
; @launch kernel=prep_kernel grid=(3164,1,1) block=(256,1,1) lds=0
; @launch kernel=qkv_kernel grid=(1536,1,1) block=(256,1,1) lds=0
; @launch kernel=mlp1_kernel grid=(176,1,1) block=(256,1,1) lds=0
; @launch kernel=mlp2_kernel grid=(64,1,1) block=(256,1,1) lds=0
; @launch kernel=chain_kernel grid=(32,1,1) block=(256,1,1) lds=163840
; @launch kernel=attn_kernel grid=(512,1,1) block=(256,1,1) lds=0
; @launch kernel=wo_kernel grid=(64,1,1) block=(256,1,1) lds=0
.amdgcn_target "amdgcn-amd-amdhsa--gfx950"
.text
.p2align 8
.globl prep_kernel
.type prep_kernel,@function
prep_kernel:
s_load_dwordx2 s[8:9], s[0:1], 112
s_waitcnt lgkmcnt(0)
s_mov_b32 s10, 268435456
s_mov_b32 s11, 0x00020000
v_and_b32 v1, 63, v0
v_lshrrev_b32 v2, 6, v0
s_nop 0
v_readfirstlane_b32 s3, v2
s_lshl_b32 s4, s2, 2
s_add_u32 s4, s4, s3
s_cmpk_lt_u32 s4, 2048
s_cbranch_scc0 Lp1
s_load_dwordx2 s[12:13], s[0:1], 0
s_waitcnt lgkmcnt(0)
s_mov_b32 s14, 2097152
s_mov_b32 s15, 0x00020000
s_lshl_b32 s5, s4, 10
v_lshlrev_b32 v3, 4, v1
v_lshlrev_b32 v63, 2, v1
buffer_load_dwordx4 v[4:7], v3, s[12:15], s5 offen
s_waitcnt vmcnt(0)
v_lshlrev_b32 v10, 16, v4
v_and_b32 v11, 0xffff0000, v4
v_lshlrev_b32 v12, 16, v5
v_and_b32 v13, 0xffff0000, v5
v_lshlrev_b32 v14, 16, v6
v_and_b32 v15, 0xffff0000, v6
v_lshlrev_b32 v16, 16, v7
v_and_b32 v17, 0xffff0000, v7
v_add_f32 v20, v10, v11
v_add_f32 v20, v20, v12
v_add_f32 v20, v20, v13
v_add_f32 v20, v20, v14
v_add_f32 v20, v20, v15
v_add_f32 v20, v20, v16
v_add_f32 v20, v20, v17
v_xor_b32 v22, 4, v63
ds_bpermute_b32 v21, v22, v20
s_waitcnt lgkmcnt(0)
v_add_f32 v20, v20, v21
v_xor_b32 v22, 8, v63
ds_bpermute_b32 v21, v22, v20
s_waitcnt lgkmcnt(0)
v_add_f32 v20, v20, v21
v_xor_b32 v22, 16, v63
ds_bpermute_b32 v21, v22, v20
s_waitcnt lgkmcnt(0)
v_add_f32 v20, v20, v21
v_xor_b32 v22, 32, v63
ds_bpermute_b32 v21, v22, v20
s_waitcnt lgkmcnt(0)
v_add_f32 v20, v20, v21
v_xor_b32 v22, 64, v63
ds_bpermute_b32 v21, v22, v20
s_waitcnt lgkmcnt(0)
v_add_f32 v20, v20, v21
v_xor_b32 v22, 128, v63
ds_bpermute_b32 v21, v22, v20
s_waitcnt lgkmcnt(0)
v_add_f32 v20, v20, v21
v_mul_f32 v20, 0x3b000000, v20
v_mov_b32 v23, 0
v_sub_f32 v24, v10, v20
v_fmac_f32 v23, v24, v24
v_sub_f32 v24, v11, v20
v_fmac_f32 v23, v24, v24
v_sub_f32 v24, v12, v20
v_fmac_f32 v23, v24, v24
v_sub_f32 v24, v13, v20
v_fmac_f32 v23, v24, v24
v_sub_f32 v24, v14, v20
v_fmac_f32 v23, v24, v24
v_sub_f32 v24, v15, v20
v_fmac_f32 v23, v24, v24
v_sub_f32 v24, v16, v20
v_fmac_f32 v23, v24, v24
v_sub_f32 v24, v17, v20
v_fmac_f32 v23, v24, v24
v_xor_b32 v22, 4, v63
ds_bpermute_b32 v21, v22, v23
s_waitcnt lgkmcnt(0)
v_add_f32 v23, v23, v21
v_xor_b32 v22, 8, v63
ds_bpermute_b32 v21, v22, v23
s_waitcnt lgkmcnt(0)
v_add_f32 v23, v23, v21
v_xor_b32 v22, 16, v63
ds_bpermute_b32 v21, v22, v23
s_waitcnt lgkmcnt(0)
v_add_f32 v23, v23, v21
v_xor_b32 v22, 32, v63
ds_bpermute_b32 v21, v22, v23
s_waitcnt lgkmcnt(0)
v_add_f32 v23, v23, v21
v_xor_b32 v22, 64, v63
ds_bpermute_b32 v21, v22, v23
s_waitcnt lgkmcnt(0)
v_add_f32 v23, v23, v21
v_xor_b32 v22, 128, v63
ds_bpermute_b32 v21, v22, v23
s_waitcnt lgkmcnt(0)
v_add_f32 v23, v23, v21
v_mul_f32 v23, 0x3b000000, v23
v_cvt_pk_bf16_f32 v23, v23, v23
v_lshlrev_b32 v23, 16, v23
v_cvt_pk_bf16_f32 v20, v20, v20
v_lshlrev_b32 v20, 16, v20
v_add_f32 v23, 0x3727c5ac, v23
v_cvt_pk_bf16_f32 v23, v23, v23
v_lshlrev_b32 v23, 16, v23
v_sqrt_f32 v23, v23
s_nop 0
v_cvt_pk_bf16_f32 v23, v23, v23
v_lshlrev_b32 v23, 16, v23
v_rcp_f32 v23, v23
s_nop 0
v_sub_f32 v10, v10, v20
v_cvt_pk_bf16_f32 v10, v10, v10
v_lshlrev_b32 v10, 16, v10
v_mul_f32 v10, v10, v23
v_cvt_pk_bf16_f32 v10, v10, v10
v_lshlrev_b32 v10, 16, v10
v_sub_f32 v11, v11, v20
v_cvt_pk_bf16_f32 v11, v11, v11
v_lshlrev_b32 v11, 16, v11
v_mul_f32 v11, v11, v23
v_cvt_pk_bf16_f32 v11, v11, v11
v_lshlrev_b32 v11, 16, v11
v_sub_f32 v12, v12, v20
v_cvt_pk_bf16_f32 v12, v12, v12
v_lshlrev_b32 v12, 16, v12
v_mul_f32 v12, v12, v23
v_cvt_pk_bf16_f32 v12, v12, v12
v_lshlrev_b32 v12, 16, v12
v_sub_f32 v13, v13, v20
v_cvt_pk_bf16_f32 v13, v13, v13
v_lshlrev_b32 v13, 16, v13
v_mul_f32 v13, v13, v23
v_cvt_pk_bf16_f32 v13, v13, v13
v_lshlrev_b32 v13, 16, v13
v_sub_f32 v14, v14, v20
v_cvt_pk_bf16_f32 v14, v14, v14
v_lshlrev_b32 v14, 16, v14
v_mul_f32 v14, v14, v23
v_cvt_pk_bf16_f32 v14, v14, v14
v_lshlrev_b32 v14, 16, v14
v_sub_f32 v15, v15, v20
v_cvt_pk_bf16_f32 v15, v15, v15
v_lshlrev_b32 v15, 16, v15
v_mul_f32 v15, v15, v23
v_cvt_pk_bf16_f32 v15, v15, v15
v_lshlrev_b32 v15, 16, v15
v_sub_f32 v16, v16, v20
v_cvt_pk_bf16_f32 v16, v16, v16
v_lshlrev_b32 v16, 16, v16
v_mul_f32 v16, v16, v23
v_cvt_pk_bf16_f32 v16, v16, v16
v_lshlrev_b32 v16, 16, v16
v_sub_f32 v17, v17, v20
v_cvt_pk_bf16_f32 v17, v17, v17
v_lshlrev_b32 v17, 16, v17
v_mul_f32 v17, v17, v23
v_cvt_pk_bf16_f32 v17, v17, v17
v_lshlrev_b32 v17, 16, v17
v_cvt_pk_bf16_f32 v4, v10, v11
v_cvt_pk_bf16_f32 v5, v12, v13
v_cvt_pk_bf16_f32 v6, v14, v15
v_cvt_pk_bf16_f32 v7, v16, v17
buffer_store_dwordx4 v[4:7], v3, s[8:11], s5 offen
v_add_f32 v20, v10, v11
v_add_f32 v20, v20, v12
v_add_f32 v20, v20, v13
v_add_f32 v20, v20, v14
v_add_f32 v20, v20, v15
v_add_f32 v20, v20, v16
v_add_f32 v20, v20, v17
v_xor_b32 v22, 4, v63
ds_bpermute_b32 v21, v22, v20
s_waitcnt lgkmcnt(0)
v_add_f32 v20, v20, v21
v_xor_b32 v22, 8, v63
ds_bpermute_b32 v21, v22, v20
s_waitcnt lgkmcnt(0)
v_add_f32 v20, v20, v21
v_xor_b32 v22, 16, v63
ds_bpermute_b32 v21, v22, v20
s_waitcnt lgkmcnt(0)
v_add_f32 v20, v20, v21
v_xor_b32 v22, 32, v63
ds_bpermute_b32 v21, v22, v20
s_waitcnt lgkmcnt(0)
v_add_f32 v20, v20, v21
v_xor_b32 v22, 64, v63
ds_bpermute_b32 v21, v22, v20
s_waitcnt lgkmcnt(0)
v_add_f32 v20, v20, v21
v_xor_b32 v22, 128, v63
ds_bpermute_b32 v21, v22, v20
s_waitcnt lgkmcnt(0)
v_add_f32 v20, v20, v21
v_mul_f32 v20, 0x3b000000, v20
v_mov_b32 v23, 0
v_sub_f32 v24, v10, v20
v_fmac_f32 v23, v24, v24
v_sub_f32 v24, v11, v20
v_fmac_f32 v23, v24, v24
v_sub_f32 v24, v12, v20
v_fmac_f32 v23, v24, v24
v_sub_f32 v24, v13, v20
v_fmac_f32 v23, v24, v24
v_sub_f32 v24, v14, v20
v_fmac_f32 v23, v24, v24
v_sub_f32 v24, v15, v20
v_fmac_f32 v23, v24, v24
v_sub_f32 v24, v16, v20
v_fmac_f32 v23, v24, v24
v_sub_f32 v24, v17, v20
v_fmac_f32 v23, v24, v24
v_xor_b32 v22, 4, v63
ds_bpermute_b32 v21, v22, v23
s_waitcnt lgkmcnt(0)
v_add_f32 v23, v23, v21
v_xor_b32 v22, 8, v63
ds_bpermute_b32 v21, v22, v23
s_waitcnt lgkmcnt(0)
v_add_f32 v23, v23, v21
v_xor_b32 v22, 16, v63
ds_bpermute_b32 v21, v22, v23
s_waitcnt lgkmcnt(0)
v_add_f32 v23, v23, v21
v_xor_b32 v22, 32, v63
ds_bpermute_b32 v21, v22, v23
s_waitcnt lgkmcnt(0)
v_add_f32 v23, v23, v21
v_xor_b32 v22, 64, v63
ds_bpermute_b32 v21, v22, v23
s_waitcnt lgkmcnt(0)
v_add_f32 v23, v23, v21
v_xor_b32 v22, 128, v63
ds_bpermute_b32 v21, v22, v23
s_waitcnt lgkmcnt(0)
v_add_f32 v23, v23, v21
v_mul_f32 v23, 0x3b000000, v23
v_cvt_pk_bf16_f32 v23, v23, v23
v_lshlrev_b32 v23, 16, v23
v_cvt_pk_bf16_f32 v20, v20, v20
v_lshlrev_b32 v20, 16, v20
v_add_f32 v23, 0x3727c5ac, v23
v_cvt_pk_bf16_f32 v23, v23, v23
v_lshlrev_b32 v23, 16, v23
v_sqrt_f32 v23, v23
s_nop 0
v_cvt_pk_bf16_f32 v23, v23, v23
v_lshlrev_b32 v23, 16, v23
v_rcp_f32 v23, v23
s_nop 0
v_sub_f32 v10, v10, v20
v_cvt_pk_bf16_f32 v10, v10, v10
v_lshlrev_b32 v10, 16, v10
v_mul_f32 v10, v10, v23
v_cvt_pk_bf16_f32 v10, v10, v10
v_lshlrev_b32 v10, 16, v10
v_sub_f32 v11, v11, v20
v_cvt_pk_bf16_f32 v11, v11, v11
v_lshlrev_b32 v11, 16, v11
v_mul_f32 v11, v11, v23
v_cvt_pk_bf16_f32 v11, v11, v11
v_lshlrev_b32 v11, 16, v11
v_sub_f32 v12, v12, v20
v_cvt_pk_bf16_f32 v12, v12, v12
v_lshlrev_b32 v12, 16, v12
v_mul_f32 v12, v12, v23
v_cvt_pk_bf16_f32 v12, v12, v12
v_lshlrev_b32 v12, 16, v12
v_sub_f32 v13, v13, v20
v_cvt_pk_bf16_f32 v13, v13, v13
v_lshlrev_b32 v13, 16, v13
v_mul_f32 v13, v13, v23
v_cvt_pk_bf16_f32 v13, v13, v13
v_lshlrev_b32 v13, 16, v13
v_sub_f32 v14, v14, v20
v_cvt_pk_bf16_f32 v14, v14, v14
v_lshlrev_b32 v14, 16, v14
v_mul_f32 v14, v14, v23
v_cvt_pk_bf16_f32 v14, v14, v14
v_lshlrev_b32 v14, 16, v14
v_sub_f32 v15, v15, v20
v_cvt_pk_bf16_f32 v15, v15, v15
v_lshlrev_b32 v15, 16, v15
v_mul_f32 v15, v15, v23
v_cvt_pk_bf16_f32 v15, v15, v15
v_lshlrev_b32 v15, 16, v15
v_sub_f32 v16, v16, v20
v_cvt_pk_bf16_f32 v16, v16, v16
v_lshlrev_b32 v16, 16, v16
v_mul_f32 v16, v16, v23
v_cvt_pk_bf16_f32 v16, v16, v16
v_lshlrev_b32 v16, 16, v16
v_sub_f32 v17, v17, v20
v_cvt_pk_bf16_f32 v17, v17, v17
v_lshlrev_b32 v17, 16, v17
v_mul_f32 v17, v17, v23
v_cvt_pk_bf16_f32 v17, v17, v17
v_lshlrev_b32 v17, 16, v17
s_nop 1
v_cvt_pk_bf16_f32 v4, v10, v11
v_cvt_pk_bf16_f32 v5, v12, v13
v_cvt_pk_bf16_f32 v6, v14, v15
v_cvt_pk_bf16_f32 v7, v16, v17
s_add_u32 s5, s5, 2097152
buffer_store_dwordx4 v[4:7], v3, s[8:11], s5 offen
s_endpgm
Lp1:
s_sub_u32 s4, s4, 2048
s_cmpk_lt_u32 s4, 1040
s_cbranch_scc0 Lp2
s_lshl_b32 s5, s4, 10
s_add_u32 s5, s5, 119537664
v_lshlrev_b32 v3, 4, v1
v_mov_b32 v4, 0
v_mov_b32 v5, 0
v_mov_b32 v6, 0
v_mov_b32 v7, 0
buffer_store_dwordx4 v[4:7], v3, s[8:11], s5 offen
s_endpgm
Lp2:
s_sub_u32 s4, s4, 1040
s_mov_b32 s6, 2048
s_cmp_lt_u32 s4, s6
s_cbranch_scc0 Lm0
s_load_dwordx2 s[12:13], s[0:1], 16
s_waitcnt lgkmcnt(0)
s_mov_b32 s14, 4194304
s_mov_b32 s15, 0x00020000
s_lshr_b32 s7, s4, 4
s_and_b32 s5, s4, 15
v_lshrrev_b32 v2, 4, v1
v_and_b32 v3, 15, v1
v_mul_u32_u24 v4, 65536, v2
v_lshl_add_u32 v4, v3, 2, v4
s_mul_i32 s16, s5, 262144
s_lshl_b32 s17, s7, 6
s_add_u32 s16, s16, s17
buffer_load_dword v10, v4, s[12:15], s16 offen offset:0
s_add_u32 s16, s16, 8192
buffer_load_dword v11, v4, s[12:15], s16 offen offset:0
s_add_u32 s16, s16, 8192
buffer_load_dword v12, v4, s[12:15], s16 offen offset:0
s_add_u32 s16, s16, 8192
buffer_load_dword v13, v4, s[12:15], s16 offen offset:0
s_add_u32 s16, s16, 8192
buffer_load_dword v14, v4, s[12:15], s16 offen offset:0
s_add_u32 s16, s16, 8192
buffer_load_dword v15, v4, s[12:15], s16 offen offset:0
s_add_u32 s16, s16, 8192
buffer_load_dword v16, v4, s[12:15], s16 offen offset:0
s_add_u32 s16, s16, 8192
buffer_load_dword v17, v4, s[12:15], s16 offen offset:0
s_add_u32 s16, s16, 8192
s_waitcnt vmcnt(0)
s_mov_b32 s18, 84148480
s_mov_b32 s19, 117834498
v_perm_b32 v20, v11, v10, s18
v_perm_b32 v24, v11, v10, s19
v_perm_b32 v21, v13, v12, s18
v_perm_b32 v25, v13, v12, s19
v_perm_b32 v22, v15, v14, s18
v_perm_b32 v26, v15, v14, s19
v_perm_b32 v23, v17, v16, s18
v_perm_b32 v27, v17, v16, s19
v_lshrrev_b32 v5, 3, v3
v_mul_u32_u24 v5, 16384, v5
v_lshlrev_b32 v6, 8, v2
v_add_u32 v5, v5, v6
v_and_b32 v6, 7, v3
v_lshl_add_u32 v5, v6, 5, v5
s_mul_i32 s16, s7, 32768
s_lshl_b32 s17, s5, 10
s_add_u32 s16, s16, s17
s_add_u32 s16, s16, 4194304
buffer_store_dwordx4 v[20:23], v5, s[8:11], s16 offen
buffer_store_dwordx4 v[24:27], v5, s[8:11], s16 offen offset:16
s_endpgm
Lm0:
s_sub_u32 s4, s4, 2048
s_mov_b32 s6, 2048
s_cmp_lt_u32 s4, s6
s_cbranch_scc0 Lm1
s_load_dwordx2 s[12:13], s[0:1], 24
s_waitcnt lgkmcnt(0)
s_mov_b32 s14, 4194304
s_mov_b32 s15, 0x00020000
s_lshr_b32 s7, s4, 4
s_and_b32 s5, s4, 15
v_lshrrev_b32 v2, 4, v1
v_and_b32 v3, 15, v1
v_mul_u32_u24 v4, 65536, v2
v_lshl_add_u32 v4, v3, 2, v4
s_mul_i32 s16, s5, 262144
s_lshl_b32 s17, s7, 6
s_add_u32 s16, s16, s17
buffer_load_dword v10, v4, s[12:15], s16 offen offset:0
s_add_u32 s16, s16, 8192
buffer_load_dword v11, v4, s[12:15], s16 offen offset:0
s_add_u32 s16, s16, 8192
buffer_load_dword v12, v4, s[12:15], s16 offen offset:0
s_add_u32 s16, s16, 8192
buffer_load_dword v13, v4, s[12:15], s16 offen offset:0
s_add_u32 s16, s16, 8192
buffer_load_dword v14, v4, s[12:15], s16 offen offset:0
s_add_u32 s16, s16, 8192
buffer_load_dword v15, v4, s[12:15], s16 offen offset:0
s_add_u32 s16, s16, 8192
buffer_load_dword v16, v4, s[12:15], s16 offen offset:0
s_add_u32 s16, s16, 8192
buffer_load_dword v17, v4, s[12:15], s16 offen offset:0
s_add_u32 s16, s16, 8192
s_waitcnt vmcnt(0)
s_mov_b32 s18, 84148480
s_mov_b32 s19, 117834498
v_perm_b32 v20, v11, v10, s18
v_perm_b32 v24, v11, v10, s19
v_perm_b32 v21, v13, v12, s18
v_perm_b32 v25, v13, v12, s19
v_perm_b32 v22, v15, v14, s18
v_perm_b32 v26, v15, v14, s19
v_perm_b32 v23, v17, v16, s18
v_perm_b32 v27, v17, v16, s19
v_lshrrev_b32 v5, 3, v3
v_mul_u32_u24 v5, 16384, v5
v_lshlrev_b32 v6, 8, v2
v_add_u32 v5, v5, v6
v_and_b32 v6, 7, v3
v_lshl_add_u32 v5, v6, 5, v5
s_mul_i32 s16, s7, 32768
s_lshl_b32 s17, s5, 10
s_add_u32 s16, s16, s17
s_add_u32 s16, s16, 8388608
buffer_store_dwordx4 v[20:23], v5, s[8:11], s16 offen
buffer_store_dwordx4 v[24:27], v5, s[8:11], s16 offen offset:16
s_endpgm
Lm1:
s_sub_u32 s4, s4, 2048
s_mov_b32 s6, 2048
s_cmp_lt_u32 s4, s6
s_cbranch_scc0 Lm2
s_load_dwordx2 s[12:13], s[0:1], 32
s_waitcnt lgkmcnt(0)
s_mov_b32 s14, 4194304
s_mov_b32 s15, 0x00020000
s_lshr_b32 s7, s4, 4
s_and_b32 s5, s4, 15
v_lshrrev_b32 v2, 4, v1
v_and_b32 v3, 15, v1
v_mul_u32_u24 v4, 65536, v2
v_lshl_add_u32 v4, v3, 2, v4
s_mul_i32 s16, s5, 262144
s_lshl_b32 s17, s7, 6
s_add_u32 s16, s16, s17
buffer_load_dword v10, v4, s[12:15], s16 offen offset:0
s_add_u32 s16, s16, 8192
buffer_load_dword v11, v4, s[12:15], s16 offen offset:0
s_add_u32 s16, s16, 8192
buffer_load_dword v12, v4, s[12:15], s16 offen offset:0
s_add_u32 s16, s16, 8192
buffer_load_dword v13, v4, s[12:15], s16 offen offset:0
s_add_u32 s16, s16, 8192
buffer_load_dword v14, v4, s[12:15], s16 offen offset:0
s_add_u32 s16, s16, 8192
buffer_load_dword v15, v4, s[12:15], s16 offen offset:0
s_add_u32 s16, s16, 8192
buffer_load_dword v16, v4, s[12:15], s16 offen offset:0
s_add_u32 s16, s16, 8192
buffer_load_dword v17, v4, s[12:15], s16 offen offset:0
s_add_u32 s16, s16, 8192
s_waitcnt vmcnt(0)
s_mov_b32 s18, 84148480
s_mov_b32 s19, 117834498
v_perm_b32 v20, v11, v10, s18
v_perm_b32 v24, v11, v10, s19
v_perm_b32 v21, v13, v12, s18
v_perm_b32 v25, v13, v12, s19
v_perm_b32 v22, v15, v14, s18
v_perm_b32 v26, v15, v14, s19
v_perm_b32 v23, v17, v16, s18
v_perm_b32 v27, v17, v16, s19
v_lshrrev_b32 v5, 3, v3
v_mul_u32_u24 v5, 16384, v5
v_lshlrev_b32 v6, 8, v2
v_add_u32 v5, v5, v6
v_and_b32 v6, 7, v3
v_lshl_add_u32 v5, v6, 5, v5
s_mul_i32 s16, s7, 32768
s_lshl_b32 s17, s5, 10
s_add_u32 s16, s16, s17
s_add_u32 s16, s16, 12582912
buffer_store_dwordx4 v[20:23], v5, s[8:11], s16 offen
buffer_store_dwordx4 v[24:27], v5, s[8:11], s16 offen offset:16
s_endpgm
Lm2:
s_sub_u32 s4, s4, 2048
s_mov_b32 s6, 2048
s_cmp_lt_u32 s4, s6
s_cbranch_scc0 Lm3
s_load_dwordx2 s[12:13], s[0:1], 40
s_waitcnt lgkmcnt(0)
s_mov_b32 s14, 4194304
s_mov_b32 s15, 0x00020000
s_lshr_b32 s7, s4, 7
s_and_b32 s5, s4, 127
v_lshrrev_b32 v2, 4, v1
v_and_b32 v3, 15, v1
v_mul_u32_u24 v4, 8192, v2
v_lshl_add_u32 v4, v3, 2, v4
s_mul_i32 s16, s5, 32768
s_lshl_b32 s17, s7, 6
s_add_u32 s16, s16, s17
buffer_load_dword v10, v4, s[12:15], s16 offen offset:0
s_add_u32 s16, s16, 1024
buffer_load_dword v11, v4, s[12:15], s16 offen offset:0
s_add_u32 s16, s16, 1024
buffer_load_dword v12, v4, s[12:15], s16 offen offset:0
s_add_u32 s16, s16, 1024
buffer_load_dword v13, v4, s[12:15], s16 offen offset:0
s_add_u32 s16, s16, 1024
buffer_load_dword v14, v4, s[12:15], s16 offen offset:0
s_add_u32 s16, s16, 1024
buffer_load_dword v15, v4, s[12:15], s16 offen offset:0
s_add_u32 s16, s16, 1024
buffer_load_dword v16, v4, s[12:15], s16 offen offset:0
s_add_u32 s16, s16, 1024
buffer_load_dword v17, v4, s[12:15], s16 offen offset:0
s_add_u32 s16, s16, 1024
s_waitcnt vmcnt(0)
s_mov_b32 s18, 84148480
s_mov_b32 s19, 117834498
v_perm_b32 v20, v11, v10, s18
v_perm_b32 v24, v11, v10, s19
v_perm_b32 v21, v13, v12, s18
v_perm_b32 v25, v13, v12, s19
v_perm_b32 v22, v15, v14, s18
v_perm_b32 v26, v15, v14, s19
v_perm_b32 v23, v17, v16, s18
v_perm_b32 v27, v17, v16, s19
v_lshrrev_b32 v5, 3, v3
v_mul_u32_u24 v5, 131072, v5
v_lshlrev_b32 v6, 8, v2
v_add_u32 v5, v5, v6
v_and_b32 v6, 7, v3
v_lshl_add_u32 v5, v6, 5, v5
s_mul_i32 s16, s7, 262144
s_lshl_b32 s17, s5, 10
s_add_u32 s16, s16, s17
s_add_u32 s16, s16, 16777216
buffer_store_dwordx4 v[20:23], v5, s[8:11], s16 offen
buffer_store_dwordx4 v[24:27], v5, s[8:11], s16 offen offset:16
s_endpgm
Lm3:
s_sub_u32 s4, s4, 2048
s_mov_b32 s6, 688
s_cmp_lt_u32 s4, s6
s_cbranch_scc0 Lm4
s_load_dwordx2 s[12:13], s[0:1], 64
s_waitcnt lgkmcnt(0)
s_mov_b32 s14, 1409024
s_mov_b32 s15, 0x00020000
s_lshr_b32 s7, s4, 4
s_and_b32 s5, s4, 15
v_lshrrev_b32 v2, 4, v1
v_and_b32 v3, 15, v1
v_mul_u32_u24 v4, 22016, v2
v_lshl_add_u32 v4, v3, 2, v4
s_mul_i32 s16, s5, 88064
s_lshl_b32 s17, s7, 6
s_add_u32 s16, s16, s17
buffer_load_dword v10, v4, s[12:15], s16 offen offset:0
s_add_u32 s16, s16, 2752
buffer_load_dword v11, v4, s[12:15], s16 offen offset:0
s_add_u32 s16, s16, 2752
buffer_load_dword v12, v4, s[12:15], s16 offen offset:0
s_add_u32 s16, s16, 2752
buffer_load_dword v13, v4, s[12:15], s16 offen offset:0
s_add_u32 s16, s16, 2752
buffer_load_dword v14, v4, s[12:15], s16 offen offset:0
s_add_u32 s16, s16, 2752
buffer_load_dword v15, v4, s[12:15], s16 offen offset:0
s_add_u32 s16, s16, 2752
buffer_load_dword v16, v4, s[12:15], s16 offen offset:0
s_add_u32 s16, s16, 2752
buffer_load_dword v17, v4, s[12:15], s16 offen offset:0
s_add_u32 s16, s16, 2752
s_waitcnt vmcnt(0)
s_mov_b32 s18, 84148480
s_mov_b32 s19, 117834498
v_perm_b32 v20, v11, v10, s18
v_perm_b32 v24, v11, v10, s19
v_perm_b32 v21, v13, v12, s18
v_perm_b32 v25, v13, v12, s19
v_perm_b32 v22, v15, v14, s18
v_perm_b32 v26, v15, v14, s19
v_perm_b32 v23, v17, v16, s18
v_perm_b32 v27, v17, v16, s19
v_lshrrev_b32 v5, 3, v3
v_mul_u32_u24 v5, 16384, v5
v_lshlrev_b32 v6, 8, v2
v_add_u32 v5, v5, v6
v_and_b32 v6, 7, v3
v_lshl_add_u32 v5, v6, 5, v5
s_mul_i32 s16, s7, 32768
s_lshl_b32 s17, s5, 10
s_add_u32 s16, s16, s17
s_add_u32 s16, s16, 20971520
buffer_store_dwordx4 v[20:23], v5, s[8:11], s16 offen
buffer_store_dwordx4 v[24:27], v5, s[8:11], s16 offen offset:16
s_endpgm
Lm4:
s_sub_u32 s4, s4, 688
s_mov_b32 s6, 688
s_cmp_lt_u32 s4, s6
s_cbranch_scc0 Lm5
s_load_dwordx2 s[12:13], s[0:1], 80
s_waitcnt lgkmcnt(0)
s_mov_b32 s14, 1409024
s_mov_b32 s15, 0x00020000
s_mov_b32 s6, 99882961
s_mul_hi_u32 s7, s4, s6
s_mul_i32 s5, s7, 43
s_sub_u32 s5, s4, s5
v_lshrrev_b32 v2, 4, v1
v_and_b32 v3, 15, v1
v_mul_u32_u24 v4, 8192, v2
v_lshl_add_u32 v4, v3, 2, v4
s_mul_i32 s16, s5, 32768
s_lshl_b32 s17, s7, 6
s_add_u32 s16, s16, s17
buffer_load_dword v10, v4, s[12:15], s16 offen offset:0
s_add_u32 s16, s16, 1024
buffer_load_dword v11, v4, s[12:15], s16 offen offset:0
s_add_u32 s16, s16, 1024
buffer_load_dword v12, v4, s[12:15], s16 offen offset:0
s_add_u32 s16, s16, 1024
buffer_load_dword v13, v4, s[12:15], s16 offen offset:0
s_add_u32 s16, s16, 1024
buffer_load_dword v14, v4, s[12:15], s16 offen offset:0
s_add_u32 s16, s16, 1024
buffer_load_dword v15, v4, s[12:15], s16 offen offset:0
s_add_u32 s16, s16, 1024
buffer_load_dword v16, v4, s[12:15], s16 offen offset:0
s_add_u32 s16, s16, 1024
buffer_load_dword v17, v4, s[12:15], s16 offen offset:0
s_add_u32 s16, s16, 1024
s_waitcnt vmcnt(0)
s_mov_b32 s18, 84148480
s_mov_b32 s19, 117834498
v_perm_b32 v20, v11, v10, s18
v_perm_b32 v24, v11, v10, s19
v_perm_b32 v21, v13, v12, s18
v_perm_b32 v25, v13, v12, s19
v_perm_b32 v22, v15, v14, s18
v_perm_b32 v26, v15, v14, s19
v_perm_b32 v23, v17, v16, s18
v_perm_b32 v27, v17, v16, s19
v_lshrrev_b32 v5, 3, v3
v_mul_u32_u24 v5, 44032, v5
v_lshlrev_b32 v6, 8, v2
v_add_u32 v5, v5, v6
v_and_b32 v6, 7, v3
v_lshl_add_u32 v5, v6, 5, v5
s_mul_i32 s16, s7, 88064
s_lshl_b32 s17, s5, 10
s_add_u32 s16, s16, s17
s_add_u32 s16, s16, 23068672
buffer_store_dwordx4 v[20:23], v5, s[8:11], s16 offen
buffer_store_dwordx4 v[24:27], v5, s[8:11], s16 offen offset:16
s_endpgm
Lm5:
s_sub_u32 s4, s4, 688
s_endpgm
.p2align 8
.globl qkv_kernel
.type qkv_kernel,@function
qkv_kernel:
s_load_dwordx2 s[8:9], s[0:1], 112
s_waitcnt lgkmcnt(0)
s_mov_b32 s10, 268435456
s_mov_b32 s11, 0x00020000
s_mov_b32 s4, 1536
s_cmp_ge_u32 s2, s4
s_cbranch_scc1 Lend_qkv_kernel
s_and_b32 s5, s2, 15
s_lshr_b32 s6, s2, 4
v_lshrrev_b32 v2, 6, v0
s_nop 0
v_readfirstlane_b32 s3, v2
v_and_b32 v1, 63, v0
s_lshr_b32 s7, s3, 1
s_lshl_b32 s7, s7, 6
s_lshl_b32 s20, s5, 7
s_add_u32 s20, s20, s7
s_and_b32 s7, s3, 1
s_lshl_b32 s7, s7, 2
s_lshl_b32 s21, s6, 3
s_add_u32 s21, s21, s7
v_and_b32 v96, 15, v1
v_lshrrev_b32 v97, 4, v1
v_add_u32 v98, s20, v96
v_mul_u32_u24 v98, 1024, v98
v_lshl_add_u32 v98, v97, 4, v98
v_lshlrev_b32 v99, 4, v1
s_cmp_ge_u32 s6, 64
s_cbranch_scc1 Lv
s_mov_b32 s28, 33554432
s_cmp_ge_u32 s6, 32
s_cselect_b32 s27, 50323456, s28
v_add_u32 v100, 0, v98
v_add_u32 v101, 16384, v98
v_add_u32 v102, 32768, v98
v_add_u32 v103, 49152, v98
s_add_u32 s22, s21, 0
s_mul_i32 s22, s22, 16384
s_add_u32 s22, s22, 4194304
v_add_u32 v104, s22, v99
s_add_u32 s22, s21, 1
s_mul_i32 s22, s22, 16384
s_add_u32 s22, s22, 4194304
v_add_u32 v105, s22, v99
s_add_u32 s22, s21, 2
s_mul_i32 s22, s22, 16384
s_add_u32 s22, s22, 4194304
v_add_u32 v106, s22, v99
s_add_u32 s22, s21, 3
s_mul_i32 s22, s22, 16384
s_add_u32 s22, s22, 4194304
v_add_u32 v107, s22, v99
v_mov_b32 v0, 0
v_mov_b32 v1, 0
v_mov_b32 v2, 0
v_mov_b32 v3, 0
v_mov_b32 v4, 0
v_mov_b32 v5, 0
v_mov_b32 v6, 0
v_mov_b32 v7, 0
v_mov_b32 v8, 0
v_mov_b32 v9, 0
v_mov_b32 v10, 0
v_mov_b32 v11, 0
v_mov_b32 v12, 0
v_mov_b32 v13, 0
v_mov_b32 v14, 0
v_mov_b32 v15, 0
v_mov_b32 v16, 0
v_mov_b32 v17, 0
v_mov_b32 v18, 0
v_mov_b32 v19, 0
v_mov_b32 v20, 0
v_mov_b32 v21, 0
v_mov_b32 v22, 0
v_mov_b32 v23, 0
v_mov_b32 v24, 0
v_mov_b32 v25, 0
v_mov_b32 v26, 0
v_mov_b32 v27, 0
v_mov_b32 v28, 0
v_mov_b32 v29, 0
v_mov_b32 v30, 0
v_mov_b32 v31, 0
v_mov_b32 v32, 0
v_mov_b32 v33, 0
v_mov_b32 v34, 0
v_mov_b32 v35, 0
v_mov_b32 v36, 0
v_mov_b32 v37, 0
v_mov_b32 v38, 0
v_mov_b32 v39, 0
v_mov_b32 v40, 0
v_mov_b32 v41, 0
v_mov_b32 v42, 0
v_mov_b32 v43, 0
v_mov_b32 v44, 0
v_mov_b32 v45, 0
v_mov_b32 v46, 0
v_mov_b32 v47, 0
v_mov_b32 v48, 0
v_mov_b32 v49, 0
v_mov_b32 v50, 0
v_mov_b32 v51, 0
v_mov_b32 v52, 0
v_mov_b32 v53, 0
v_mov_b32 v54, 0
v_mov_b32 v55, 0
v_mov_b32 v56, 0
v_mov_b32 v57, 0
v_mov_b32 v58, 0
v_mov_b32 v59, 0
v_mov_b32 v60, 0
v_mov_b32 v61, 0
v_mov_b32 v62, 0
v_mov_b32 v63, 0
s_mov_b32 s24, 0
s_mov_b32 s25, 0
s_mov_b32 s26, 8
buffer_load_dwordx4 v[108:111], v100, s[8:11], s24 offen
buffer_load_dwordx4 v[112:115], v101, s[8:11], s24 offen
buffer_load_dwordx4 v[116:119], v102, s[8:11], s24 offen
buffer_load_dwordx4 v[120:123], v103, s[8:11], s24 offen
buffer_load_dwordx4 v[124:127], v104, s[8:11], s25 offen
buffer_load_dwordx4 v[128:131], v105, s[8:11], s25 offen
buffer_load_dwordx4 v[132:135], v106, s[8:11], s25 offen
buffer_load_dwordx4 v[136:139], v107, s[8:11], s25 offen
s_add_u32 s24, s24, 64
s_add_u32 s25, s25, 1024
Lqk:
buffer_load_dwordx4 v[140:143], v100, s[8:11], s24 offen
buffer_load_dwordx4 v[144:147], v101, s[8:11], s24 offen
buffer_load_dwordx4 v[148:151], v102, s[8:11], s24 offen
buffer_load_dwordx4 v[152:155], v103, s[8:11], s24 offen
buffer_load_dwordx4 v[156:159], v104, s[8:11], s25 offen
buffer_load_dwordx4 v[160:163], v105, s[8:11], s25 offen
buffer_load_dwordx4 v[164:167], v106, s[8:11], s25 offen
buffer_load_dwordx4 v[168:171], v107, s[8:11], s25 offen
s_add_u32 s24, s24, 64
s_add_u32 s25, s25, 1024
s_waitcnt vmcnt(8)
v_mfma_f32_16x16x32_bf16 v[0:3], v[124:127], v[108:111], v[0:3]
v_mfma_f32_16x16x32_bf16 v[4:7], v[128:131], v[108:111], v[4:7]
v_mfma_f32_16x16x32_bf16 v[8:11], v[132:135], v[108:111], v[8:11]
v_mfma_f32_16x16x32_bf16 v[12:15], v[136:139], v[108:111], v[12:15]
v_mfma_f32_16x16x32_bf16 v[16:19], v[124:127], v[112:115], v[16:19]
v_mfma_f32_16x16x32_bf16 v[20:23], v[128:131], v[112:115], v[20:23]
v_mfma_f32_16x16x32_bf16 v[24:27], v[132:135], v[112:115], v[24:27]
v_mfma_f32_16x16x32_bf16 v[28:31], v[136:139], v[112:115], v[28:31]
v_mfma_f32_16x16x32_bf16 v[32:35], v[124:127], v[116:119], v[32:35]
v_mfma_f32_16x16x32_bf16 v[36:39], v[128:131], v[116:119], v[36:39]
v_mfma_f32_16x16x32_bf16 v[40:43], v[132:135], v[116:119], v[40:43]
v_mfma_f32_16x16x32_bf16 v[44:47], v[136:139], v[116:119], v[44:47]
v_mfma_f32_16x16x32_bf16 v[48:51], v[124:127], v[120:123], v[48:51]
v_mfma_f32_16x16x32_bf16 v[52:55], v[128:131], v[120:123], v[52:55]
v_mfma_f32_16x16x32_bf16 v[56:59], v[132:135], v[120:123], v[56:59]
v_mfma_f32_16x16x32_bf16 v[60:63], v[136:139], v[120:123], v[60:63]
buffer_load_dwordx4 v[108:111], v100, s[8:11], s24 offen
buffer_load_dwordx4 v[112:115], v101, s[8:11], s24 offen
buffer_load_dwordx4 v[116:119], v102, s[8:11], s24 offen
buffer_load_dwordx4 v[120:123], v103, s[8:11], s24 offen
buffer_load_dwordx4 v[124:127], v104, s[8:11], s25 offen
buffer_load_dwordx4 v[128:131], v105, s[8:11], s25 offen
buffer_load_dwordx4 v[132:135], v106, s[8:11], s25 offen
buffer_load_dwordx4 v[136:139], v107, s[8:11], s25 offen
s_add_u32 s24, s24, 64
s_add_u32 s25, s25, 1024
s_waitcnt vmcnt(8)
v_mfma_f32_16x16x32_bf16 v[0:3], v[156:159], v[140:143], v[0:3]
v_mfma_f32_16x16x32_bf16 v[4:7], v[160:163], v[140:143], v[4:7]
v_mfma_f32_16x16x32_bf16 v[8:11], v[164:167], v[140:143], v[8:11]
v_mfma_f32_16x16x32_bf16 v[12:15], v[168:171], v[140:143], v[12:15]
v_mfma_f32_16x16x32_bf16 v[16:19], v[156:159], v[144:147], v[16:19]
v_mfma_f32_16x16x32_bf16 v[20:23], v[160:163], v[144:147], v[20:23]
v_mfma_f32_16x16x32_bf16 v[24:27], v[164:167], v[144:147], v[24:27]
v_mfma_f32_16x16x32_bf16 v[28:31], v[168:171], v[144:147], v[28:31]
v_mfma_f32_16x16x32_bf16 v[32:35], v[156:159], v[148:151], v[32:35]
v_mfma_f32_16x16x32_bf16 v[36:39], v[160:163], v[148:151], v[36:39]
v_mfma_f32_16x16x32_bf16 v[40:43], v[164:167], v[148:151], v[40:43]
v_mfma_f32_16x16x32_bf16 v[44:47], v[168:171], v[148:151], v[44:47]
v_mfma_f32_16x16x32_bf16 v[48:51], v[156:159], v[152:155], v[48:51]
v_mfma_f32_16x16x32_bf16 v[52:55], v[160:163], v[152:155], v[52:55]
v_mfma_f32_16x16x32_bf16 v[56:59], v[164:167], v[152:155], v[56:59]
v_mfma_f32_16x16x32_bf16 v[60:63], v[168:171], v[152:155], v[60:63]
s_sub_u32 s26, s26, 1
s_cmp_lg_u32 s26, 0
s_cbranch_scc1 Lqk
s_waitcnt vmcnt(0)
s_nop 15
v_add_u32 v94, s20, v96
v_mul_u32_u24 v94, 8192, v94
v_lshl_add_u32 v94, v97, 3, v94
s_add_u32 s22, s21, 0
s_lshl_b32 s22, s22, 5
s_add_u32 s23, s22, s27
v_cvt_pk_bf16_f32 v0, v0, v1
v_cvt_pk_bf16_f32 v1, v2, v3
buffer_store_dwordx2 v[0:1], v94, s[8:11], s23 offen
s_add_u32 s23, s23, 131072
v_cvt_pk_bf16_f32 v16, v16, v17
v_cvt_pk_bf16_f32 v17, v18, v19
buffer_store_dwordx2 v[16:17], v94, s[8:11], s23 offen
s_add_u32 s23, s23, 131072
v_cvt_pk_bf16_f32 v32, v32, v33
v_cvt_pk_bf16_f32 v33, v34, v35
buffer_store_dwordx2 v[32:33], v94, s[8:11], s23 offen
s_add_u32 s23, s23, 131072
v_cvt_pk_bf16_f32 v48, v48, v49
v_cvt_pk_bf16_f32 v49, v50, v51
buffer_store_dwordx2 v[48:49], v94, s[8:11], s23 offen
s_add_u32 s23, s23, 131072
s_add_u32 s22, s21, 1
s_lshl_b32 s22, s22, 5
s_add_u32 s23, s22, s27
v_cvt_pk_bf16_f32 v4, v4, v5
v_cvt_pk_bf16_f32 v5, v6, v7
buffer_store_dwordx2 v[4:5], v94, s[8:11], s23 offen
s_add_u32 s23, s23, 131072
v_cvt_pk_bf16_f32 v20, v20, v21
v_cvt_pk_bf16_f32 v21, v22, v23
buffer_store_dwordx2 v[20:21], v94, s[8:11], s23 offen
s_add_u32 s23, s23, 131072
v_cvt_pk_bf16_f32 v36, v36, v37
v_cvt_pk_bf16_f32 v37, v38, v39
buffer_store_dwordx2 v[36:37], v94, s[8:11], s23 offen
s_add_u32 s23, s23, 131072
v_cvt_pk_bf16_f32 v52, v52, v53
v_cvt_pk_bf16_f32 v53, v54, v55
buffer_store_dwordx2 v[52:53], v94, s[8:11], s23 offen
s_add_u32 s23, s23, 131072
s_add_u32 s22, s21, 2
s_lshl_b32 s22, s22, 5
s_add_u32 s23, s22, s27
v_cvt_pk_bf16_f32 v8, v8, v9
v_cvt_pk_bf16_f32 v9, v10, v11
buffer_store_dwordx2 v[8:9], v94, s[8:11], s23 offen
s_add_u32 s23, s23, 131072
v_cvt_pk_bf16_f32 v24, v24, v25
v_cvt_pk_bf16_f32 v25, v26, v27
buffer_store_dwordx2 v[24:25], v94, s[8:11], s23 offen
s_add_u32 s23, s23, 131072
v_cvt_pk_bf16_f32 v40, v40, v41
v_cvt_pk_bf16_f32 v41, v42, v43
buffer_store_dwordx2 v[40:41], v94, s[8:11], s23 offen
s_add_u32 s23, s23, 131072
v_cvt_pk_bf16_f32 v56, v56, v57
v_cvt_pk_bf16_f32 v57, v58, v59
buffer_store_dwordx2 v[56:57], v94, s[8:11], s23 offen
s_add_u32 s23, s23, 131072
s_add_u32 s22, s21, 3
s_lshl_b32 s22, s22, 5
s_add_u32 s23, s22, s27
v_cvt_pk_bf16_f32 v12, v12, v13
v_cvt_pk_bf16_f32 v13, v14, v15
buffer_store_dwordx2 v[12:13], v94, s[8:11], s23 offen
s_add_u32 s23, s23, 131072
v_cvt_pk_bf16_f32 v28, v28, v29
v_cvt_pk_bf16_f32 v29, v30, v31
buffer_store_dwordx2 v[28:29], v94, s[8:11], s23 offen
s_add_u32 s23, s23, 131072
v_cvt_pk_bf16_f32 v44, v44, v45
v_cvt_pk_bf16_f32 v45, v46, v47
buffer_store_dwordx2 v[44:45], v94, s[8:11], s23 offen
s_add_u32 s23, s23, 131072
v_cvt_pk_bf16_f32 v60, v60, v61
v_cvt_pk_bf16_f32 v61, v62, v63
buffer_store_dwordx2 v[60:61], v94, s[8:11], s23 offen
s_add_u32 s23, s23, 131072
s_endpgm
Lv:
v_add_u32 v100, 0, v98
v_add_u32 v101, 16384, v98
v_add_u32 v102, 32768, v98
v_add_u32 v103, 49152, v98
s_add_u32 s22, s21, 0
s_mul_i32 s22, s22, 16384
s_add_u32 s22, s22, 4194304
v_add_u32 v104, s22, v99
s_add_u32 s22, s21, 1
s_mul_i32 s22, s22, 16384
s_add_u32 s22, s22, 4194304
v_add_u32 v105, s22, v99
s_add_u32 s22, s21, 2
s_mul_i32 s22, s22, 16384
s_add_u32 s22, s22, 4194304
v_add_u32 v106, s22, v99
s_add_u32 s22, s21, 3
s_mul_i32 s22, s22, 16384
s_add_u32 s22, s22, 4194304
v_add_u32 v107, s22, v99
v_mov_b32 v0, 0
v_mov_b32 v1, 0
v_mov_b32 v2, 0
v_mov_b32 v3, 0
v_mov_b32 v4, 0
v_mov_b32 v5, 0
v_mov_b32 v6, 0
v_mov_b32 v7, 0
v_mov_b32 v8, 0
v_mov_b32 v9, 0
v_mov_b32 v10, 0
v_mov_b32 v11, 0
v_mov_b32 v12, 0
v_mov_b32 v13, 0
v_mov_b32 v14, 0
v_mov_b32 v15, 0
v_mov_b32 v16, 0
v_mov_b32 v17, 0
v_mov_b32 v18, 0
v_mov_b32 v19, 0
v_mov_b32 v20, 0
v_mov_b32 v21, 0
v_mov_b32 v22, 0
v_mov_b32 v23, 0
v_mov_b32 v24, 0
v_mov_b32 v25, 0
v_mov_b32 v26, 0
v_mov_b32 v27, 0
v_mov_b32 v28, 0
v_mov_b32 v29, 0
v_mov_b32 v30, 0
v_mov_b32 v31, 0
v_mov_b32 v32, 0
v_mov_b32 v33, 0
v_mov_b32 v34, 0
v_mov_b32 v35, 0
v_mov_b32 v36, 0
v_mov_b32 v37, 0
v_mov_b32 v38, 0
v_mov_b32 v39, 0
v_mov_b32 v40, 0
v_mov_b32 v41, 0
v_mov_b32 v42, 0
v_mov_b32 v43, 0
v_mov_b32 v44, 0
v_mov_b32 v45, 0
v_mov_b32 v46, 0
v_mov_b32 v47, 0
v_mov_b32 v48, 0
v_mov_b32 v49, 0
v_mov_b32 v50, 0
v_mov_b32 v51, 0
v_mov_b32 v52, 0
v_mov_b32 v53, 0
v_mov_b32 v54, 0
v_mov_b32 v55, 0
v_mov_b32 v56, 0
v_mov_b32 v57, 0
v_mov_b32 v58, 0
v_mov_b32 v59, 0
v_mov_b32 v60, 0
v_mov_b32 v61, 0
v_mov_b32 v62, 0
v_mov_b32 v63, 0
s_mov_b32 s24, 0
s_mov_b32 s25, 0
s_mov_b32 s26, 8
buffer_load_dwordx4 v[108:111], v100, s[8:11], s24 offen
buffer_load_dwordx4 v[112:115], v101, s[8:11], s24 offen
buffer_load_dwordx4 v[116:119], v102, s[8:11], s24 offen
buffer_load_dwordx4 v[120:123], v103, s[8:11], s24 offen
buffer_load_dwordx4 v[124:127], v104, s[8:11], s25 offen
buffer_load_dwordx4 v[128:131], v105, s[8:11], s25 offen
buffer_load_dwordx4 v[132:135], v106, s[8:11], s25 offen
buffer_load_dwordx4 v[136:139], v107, s[8:11], s25 offen
s_add_u32 s24, s24, 64
s_add_u32 s25, s25, 1024
Lvloop:
buffer_load_dwordx4 v[140:143], v100, s[8:11], s24 offen
buffer_load_dwordx4 v[144:147], v101, s[8:11], s24 offen
buffer_load_dwordx4 v[148:151], v102, s[8:11], s24 offen
buffer_load_dwordx4 v[152:155], v103, s[8:11], s24 offen
buffer_load_dwordx4 v[156:159], v104, s[8:11], s25 offen
buffer_load_dwordx4 v[160:163], v105, s[8:11], s25 offen
buffer_load_dwordx4 v[164:167], v106, s[8:11], s25 offen
buffer_load_dwordx4 v[168:171], v107, s[8:11], s25 offen
s_add_u32 s24, s24, 64
s_add_u32 s25, s25, 1024
s_waitcnt vmcnt(8)
v_mfma_f32_16x16x32_bf16 v[0:3], v[108:111], v[124:127], v[0:3]
v_mfma_f32_16x16x32_bf16 v[4:7], v[108:111], v[128:131], v[4:7]
v_mfma_f32_16x16x32_bf16 v[8:11], v[108:111], v[132:135], v[8:11]
v_mfma_f32_16x16x32_bf16 v[12:15], v[108:111], v[136:139], v[12:15]
v_mfma_f32_16x16x32_bf16 v[16:19], v[112:115], v[124:127], v[16:19]
v_mfma_f32_16x16x32_bf16 v[20:23], v[112:115], v[128:131], v[20:23]
v_mfma_f32_16x16x32_bf16 v[24:27], v[112:115], v[132:135], v[24:27]
v_mfma_f32_16x16x32_bf16 v[28:31], v[112:115], v[136:139], v[28:31]
v_mfma_f32_16x16x32_bf16 v[32:35], v[116:119], v[124:127], v[32:35]
v_mfma_f32_16x16x32_bf16 v[36:39], v[116:119], v[128:131], v[36:39]
v_mfma_f32_16x16x32_bf16 v[40:43], v[116:119], v[132:135], v[40:43]
v_mfma_f32_16x16x32_bf16 v[44:47], v[116:119], v[136:139], v[44:47]
v_mfma_f32_16x16x32_bf16 v[48:51], v[120:123], v[124:127], v[48:51]
v_mfma_f32_16x16x32_bf16 v[52:55], v[120:123], v[128:131], v[52:55]
v_mfma_f32_16x16x32_bf16 v[56:59], v[120:123], v[132:135], v[56:59]
v_mfma_f32_16x16x32_bf16 v[60:63], v[120:123], v[136:139], v[60:63]
buffer_load_dwordx4 v[108:111], v100, s[8:11], s24 offen
buffer_load_dwordx4 v[112:115], v101, s[8:11], s24 offen
buffer_load_dwordx4 v[116:119], v102, s[8:11], s24 offen
buffer_load_dwordx4 v[120:123], v103, s[8:11], s24 offen
buffer_load_dwordx4 v[124:127], v104, s[8:11], s25 offen
buffer_load_dwordx4 v[128:131], v105, s[8:11], s25 offen
buffer_load_dwordx4 v[132:135], v106, s[8:11], s25 offen
buffer_load_dwordx4 v[136:139], v107, s[8:11], s25 offen
s_add_u32 s24, s24, 64
s_add_u32 s25, s25, 1024
s_waitcnt vmcnt(8)
v_mfma_f32_16x16x32_bf16 v[0:3], v[140:143], v[156:159], v[0:3]
v_mfma_f32_16x16x32_bf16 v[4:7], v[140:143], v[160:163], v[4:7]
v_mfma_f32_16x16x32_bf16 v[8:11], v[140:143], v[164:167], v[8:11]
v_mfma_f32_16x16x32_bf16 v[12:15], v[140:143], v[168:171], v[12:15]
v_mfma_f32_16x16x32_bf16 v[16:19], v[144:147], v[156:159], v[16:19]
v_mfma_f32_16x16x32_bf16 v[20:23], v[144:147], v[160:163], v[20:23]
v_mfma_f32_16x16x32_bf16 v[24:27], v[144:147], v[164:167], v[24:27]
v_mfma_f32_16x16x32_bf16 v[28:31], v[144:147], v[168:171], v[28:31]
v_mfma_f32_16x16x32_bf16 v[32:35], v[148:151], v[156:159], v[32:35]
v_mfma_f32_16x16x32_bf16 v[36:39], v[148:151], v[160:163], v[36:39]
v_mfma_f32_16x16x32_bf16 v[40:43], v[148:151], v[164:167], v[40:43]
v_mfma_f32_16x16x32_bf16 v[44:47], v[148:151], v[168:171], v[44:47]
v_mfma_f32_16x16x32_bf16 v[48:51], v[152:155], v[156:159], v[48:51]
v_mfma_f32_16x16x32_bf16 v[52:55], v[152:155], v[160:163], v[52:55]
v_mfma_f32_16x16x32_bf16 v[56:59], v[152:155], v[164:167], v[56:59]
v_mfma_f32_16x16x32_bf16 v[60:63], v[152:155], v[168:171], v[60:63]
s_sub_u32 s26, s26, 1
s_cmp_lg_u32 s26, 0
s_cbranch_scc1 Lvloop
s_waitcnt vmcnt(0)
s_nop 15
s_sub_u32 s22, s21, 512
s_lshl_b32 s22, s22, 10
s_lshr_b32 s23, s20, 5
s_lshl_b32 s23, s23, 18
s_add_u32 s22, s22, s23
s_add_u32 s22, s22, 67108864
v_lshlrev_b32 v94, 6, v96
v_lshl_add_u32 v94, v97, 3, v94
v_cvt_pk_bf16_f32 v0, v0, v1
v_cvt_pk_bf16_f32 v1, v2, v3
buffer_store_dwordx2 v[0:1], v94, s[8:11], s22 offen offset:0
v_cvt_pk_bf16_f32 v4, v4, v5
v_cvt_pk_bf16_f32 v5, v6, v7
buffer_store_dwordx2 v[4:5], v94, s[8:11], s22 offen offset:1024
v_cvt_pk_bf16_f32 v8, v8, v9
v_cvt_pk_bf16_f32 v9, v10, v11
buffer_store_dwordx2 v[8:9], v94, s[8:11], s22 offen offset:2048
v_cvt_pk_bf16_f32 v12, v12, v13
v_cvt_pk_bf16_f32 v13, v14, v15
buffer_store_dwordx2 v[12:13], v94, s[8:11], s22 offen offset:3072
v_cvt_pk_bf16_f32 v16, v16, v17
v_cvt_pk_bf16_f32 v17, v18, v19
buffer_store_dwordx2 v[16:17], v94, s[8:11], s22 offen offset:32
v_cvt_pk_bf16_f32 v20, v20, v21
v_cvt_pk_bf16_f32 v21, v22, v23
buffer_store_dwordx2 v[20:21], v94, s[8:11], s22 offen offset:1056
v_cvt_pk_bf16_f32 v24, v24, v25
v_cvt_pk_bf16_f32 v25, v26, v27
buffer_store_dwordx2 v[24:25], v94, s[8:11], s22 offen offset:2080
v_cvt_pk_bf16_f32 v28, v28, v29
v_cvt_pk_bf16_f32 v29, v30, v31
buffer_store_dwordx2 v[28:29], v94, s[8:11], s22 offen offset:3104
v_cvt_pk_bf16_f32 v32, v32, v33
v_cvt_pk_bf16_f32 v33, v34, v35
v_add_u32 v95, 262144, v94
buffer_store_dwordx2 v[32:33], v95, s[8:11], s22 offen offset:0
v_cvt_pk_bf16_f32 v36, v36, v37
v_cvt_pk_bf16_f32 v37, v38, v39
v_add_u32 v95, 262144, v94
buffer_store_dwordx2 v[36:37], v95, s[8:11], s22 offen offset:1024
v_cvt_pk_bf16_f32 v40, v40, v41
v_cvt_pk_bf16_f32 v41, v42, v43
v_add_u32 v95, 262144, v94
buffer_store_dwordx2 v[40:41], v95, s[8:11], s22 offen offset:2048
v_cvt_pk_bf16_f32 v44, v44, v45
v_cvt_pk_bf16_f32 v45, v46, v47
v_add_u32 v95, 262144, v94
buffer_store_dwordx2 v[44:45], v95, s[8:11], s22 offen offset:3072
v_cvt_pk_bf16_f32 v48, v48, v49
v_cvt_pk_bf16_f32 v49, v50, v51
v_add_u32 v95, 262144, v94
buffer_store_dwordx2 v[48:49], v95, s[8:11], s22 offen offset:32
v_cvt_pk_bf16_f32 v52, v52, v53
v_cvt_pk_bf16_f32 v53, v54, v55
v_add_u32 v95, 262144, v94
buffer_store_dwordx2 v[52:53], v95, s[8:11], s22 offen offset:1056
v_cvt_pk_bf16_f32 v56, v56, v57
v_cvt_pk_bf16_f32 v57, v58, v59
v_add_u32 v95, 262144, v94
buffer_store_dwordx2 v[56:57], v95, s[8:11], s22 offen offset:2080
v_cvt_pk_bf16_f32 v60, v60, v61
v_cvt_pk_bf16_f32 v61, v62, v63
v_add_u32 v95, 262144, v94
buffer_store_dwordx2 v[60:61], v95, s[8:11], s22 offen offset:3104
Lend_qkv_kernel:
s_endpgm
.p2align 8
.globl mlp1_kernel
.type mlp1_kernel,@function
mlp1_kernel:
s_load_dwordx2 s[8:9], s[0:1], 112
s_waitcnt lgkmcnt(0)
s_mov_b32 s10, 268435456
s_mov_b32 s11, 0x00020000
s_mov_b32 s4, 176
s_cmp_ge_u32 s2, s4
s_cbranch_scc1 Lend_mlp1_kernel
s_and_b32 s5, s2, 15
s_lshr_b32 s6, s2, 4
v_lshrrev_b32 v2, 6, v0
s_nop 0
v_readfirstlane_b32 s3, v2
v_and_b32 v1, 63, v0
s_lshr_b32 s7, s3, 1
s_lshl_b32 s7, s7, 6
s_lshl_b32 s20, s5, 7
s_add_u32 s20, s20, s7
s_and_b32 s7, s3, 1
s_lshl_b32 s7, s7, 2
s_lshl_b32 s21, s6, 3
s_add_u32 s21, s21, s7
v_and_b32 v96, 15, v1
v_lshrrev_b32 v97, 4, v1
v_add_u32 v98, s20, v96
v_mul_u32_u24 v98, 1024, v98
v_lshl_add_u32 v98, v97, 4, v98
v_lshlrev_b32 v99, 4, v1
s_load_dwordx2 s[12:13], s[0:1], 72
s_waitcnt lgkmcnt(0)
s_mov_b32 s14, 2752
s_mov_b32 s15, 0x00020000
s_mov_b32 s27, 100663296
v_add_u32 v100, 2097152, v98
v_add_u32 v101, 2113536, v98
v_add_u32 v102, 2129920, v98
v_add_u32 v103, 2146304, v98
s_add_u32 s22, s21, 0
s_mul_i32 s22, s22, 16384
s_add_u32 s22, s22, 20971520
v_add_u32 v104, s22, v99
s_add_u32 s22, s21, 1
s_mul_i32 s22, s22, 16384
s_add_u32 s22, s22, 20971520
v_add_u32 v105, s22, v99
s_add_u32 s22, s21, 2
s_mul_i32 s22, s22, 16384
s_add_u32 s22, s22, 20971520
v_add_u32 v106, s22, v99
s_add_u32 s22, s21, 3
s_mul_i32 s22, s22, 16384
s_add_u32 s22, s22, 20971520
v_add_u32 v107, s22, v99
v_mov_b32 v0, 0
v_mov_b32 v1, 0
v_mov_b32 v2, 0
v_mov_b32 v3, 0
v_mov_b32 v4, 0
v_mov_b32 v5, 0
v_mov_b32 v6, 0
v_mov_b32 v7, 0
v_mov_b32 v8, 0
v_mov_b32 v9, 0
v_mov_b32 v10, 0
v_mov_b32 v11, 0
v_mov_b32 v12, 0
v_mov_b32 v13, 0
v_mov_b32 v14, 0
v_mov_b32 v15, 0
v_mov_b32 v16, 0
v_mov_b32 v17, 0
v_mov_b32 v18, 0
v_mov_b32 v19, 0
v_mov_b32 v20, 0
v_mov_b32 v21, 0
v_mov_b32 v22, 0
v_mov_b32 v23, 0
v_mov_b32 v24, 0
v_mov_b32 v25, 0
v_mov_b32 v26, 0
v_mov_b32 v27, 0
v_mov_b32 v28, 0
v_mov_b32 v29, 0
v_mov_b32 v30, 0
v_mov_b32 v31, 0
v_mov_b32 v32, 0
v_mov_b32 v33, 0
v_mov_b32 v34, 0
v_mov_b32 v35, 0
v_mov_b32 v36, 0
v_mov_b32 v37, 0
v_mov_b32 v38, 0
v_mov_b32 v39, 0
v_mov_b32 v40, 0
v_mov_b32 v41, 0
v_mov_b32 v42, 0
v_mov_b32 v43, 0
v_mov_b32 v44, 0
v_mov_b32 v45, 0
v_mov_b32 v46, 0
v_mov_b32 v47, 0
v_mov_b32 v48, 0
v_mov_b32 v49, 0
v_mov_b32 v50, 0
v_mov_b32 v51, 0
v_mov_b32 v52, 0
v_mov_b32 v53, 0
v_mov_b32 v54, 0
v_mov_b32 v55, 0
v_mov_b32 v56, 0
v_mov_b32 v57, 0
v_mov_b32 v58, 0
v_mov_b32 v59, 0
v_mov_b32 v60, 0
v_mov_b32 v61, 0
v_mov_b32 v62, 0
v_mov_b32 v63, 0
s_mov_b32 s24, 0
s_mov_b32 s25, 0
s_mov_b32 s26, 8
buffer_load_dwordx4 v[108:111], v100, s[8:11], s24 offen
buffer_load_dwordx4 v[112:115], v101, s[8:11], s24 offen
buffer_load_dwordx4 v[116:119], v102, s[8:11], s24 offen
buffer_load_dwordx4 v[120:123], v103, s[8:11], s24 offen
buffer_load_dwordx4 v[124:127], v104, s[8:11], s25 offen
buffer_load_dwordx4 v[128:131], v105, s[8:11], s25 offen
buffer_load_dwordx4 v[132:135], v106, s[8:11], s25 offen
buffer_load_dwordx4 v[136:139], v107, s[8:11], s25 offen
s_add_u32 s24, s24, 64
s_add_u32 s25, s25, 1024
Lmmlp1_kernel:
buffer_load_dwordx4 v[140:143], v100, s[8:11], s24 offen
buffer_load_dwordx4 v[144:147], v101, s[8:11], s24 offen
buffer_load_dwordx4 v[148:151], v102, s[8:11], s24 offen
buffer_load_dwordx4 v[152:155], v103, s[8:11], s24 offen
buffer_load_dwordx4 v[156:159], v104, s[8:11], s25 offen
buffer_load_dwordx4 v[160:163], v105, s[8:11], s25 offen
buffer_load_dwordx4 v[164:167], v106, s[8:11], s25 offen
buffer_load_dwordx4 v[168:171], v107, s[8:11], s25 offen
s_add_u32 s24, s24, 64
s_add_u32 s25, s25, 1024
s_waitcnt vmcnt(8)
v_mfma_f32_16x16x32_bf16 v[0:3], v[124:127], v[108:111], v[0:3]
v_mfma_f32_16x16x32_bf16 v[4:7], v[128:131], v[108:111], v[4:7]
v_mfma_f32_16x16x32_bf16 v[8:11], v[132:135], v[108:111], v[8:11]
v_mfma_f32_16x16x32_bf16 v[12:15], v[136:139], v[108:111], v[12:15]
v_mfma_f32_16x16x32_bf16 v[16:19], v[124:127], v[112:115], v[16:19]
v_mfma_f32_16x16x32_bf16 v[20:23], v[128:131], v[112:115], v[20:23]
v_mfma_f32_16x16x32_bf16 v[24:27], v[132:135], v[112:115], v[24:27]
v_mfma_f32_16x16x32_bf16 v[28:31], v[136:139], v[112:115], v[28:31]
v_mfma_f32_16x16x32_bf16 v[32:35], v[124:127], v[116:119], v[32:35]
v_mfma_f32_16x16x32_bf16 v[36:39], v[128:131], v[116:119], v[36:39]
v_mfma_f32_16x16x32_bf16 v[40:43], v[132:135], v[116:119], v[40:43]
v_mfma_f32_16x16x32_bf16 v[44:47], v[136:139], v[116:119], v[44:47]
v_mfma_f32_16x16x32_bf16 v[48:51], v[124:127], v[120:123], v[48:51]
v_mfma_f32_16x16x32_bf16 v[52:55], v[128:131], v[120:123], v[52:55]
v_mfma_f32_16x16x32_bf16 v[56:59], v[132:135], v[120:123], v[56:59]
v_mfma_f32_16x16x32_bf16 v[60:63], v[136:139], v[120:123], v[60:63]
buffer_load_dwordx4 v[108:111], v100, s[8:11], s24 offen
buffer_load_dwordx4 v[112:115], v101, s[8:11], s24 offen
buffer_load_dwordx4 v[116:119], v102, s[8:11], s24 offen
buffer_load_dwordx4 v[120:123], v103, s[8:11], s24 offen
buffer_load_dwordx4 v[124:127], v104, s[8:11], s25 offen
buffer_load_dwordx4 v[128:131], v105, s[8:11], s25 offen
buffer_load_dwordx4 v[132:135], v106, s[8:11], s25 offen
buffer_load_dwordx4 v[136:139], v107, s[8:11], s25 offen
s_add_u32 s24, s24, 64
s_add_u32 s25, s25, 1024
s_waitcnt vmcnt(8)
v_mfma_f32_16x16x32_bf16 v[0:3], v[156:159], v[140:143], v[0:3]
v_mfma_f32_16x16x32_bf16 v[4:7], v[160:163], v[140:143], v[4:7]
v_mfma_f32_16x16x32_bf16 v[8:11], v[164:167], v[140:143], v[8:11]
v_mfma_f32_16x16x32_bf16 v[12:15], v[168:171], v[140:143], v[12:15]
v_mfma_f32_16x16x32_bf16 v[16:19], v[156:159], v[144:147], v[16:19]
v_mfma_f32_16x16x32_bf16 v[20:23], v[160:163], v[144:147], v[20:23]
v_mfma_f32_16x16x32_bf16 v[24:27], v[164:167], v[144:147], v[24:27]
v_mfma_f32_16x16x32_bf16 v[28:31], v[168:171], v[144:147], v[28:31]
v_mfma_f32_16x16x32_bf16 v[32:35], v[156:159], v[148:151], v[32:35]
v_mfma_f32_16x16x32_bf16 v[36:39], v[160:163], v[148:151], v[36:39]
v_mfma_f32_16x16x32_bf16 v[40:43], v[164:167], v[148:151], v[40:43]
v_mfma_f32_16x16x32_bf16 v[44:47], v[168:171], v[148:151], v[44:47]
v_mfma_f32_16x16x32_bf16 v[48:51], v[156:159], v[152:155], v[48:51]
v_mfma_f32_16x16x32_bf16 v[52:55], v[160:163], v[152:155], v[52:55]
v_mfma_f32_16x16x32_bf16 v[56:59], v[164:167], v[152:155], v[56:59]
v_mfma_f32_16x16x32_bf16 v[60:63], v[168:171], v[152:155], v[60:63]
s_sub_u32 s26, s26, 1
s_cmp_lg_u32 s26, 0
s_cbranch_scc1 Lmmlp1_kernel
s_waitcnt vmcnt(0)
s_nop 15
v_add_u32 v94, s20, v96
v_mul_u32_u24 v94, 2752, v94
v_lshl_add_u32 v94, v97, 3, v94
s_add_u32 s22, s21, 0
s_cmp_ge_u32 s22, 86
s_cbranch_scc1 Lskip0_mlp1_kernel
s_add_u32 s22, s21, 0
s_lshl_b32 s22, s22, 5
v_lshlrev_b32 v95, 3, v97
buffer_load_dwordx2 v[84:85], v95, s[12:15], s22 offen
s_waitcnt vmcnt(0)
v_lshlrev_b32 v86, 16, v84
v_and_b32 v87, 0xffff0000, v84
v_lshlrev_b32 v88, 16, v85
v_and_b32 v89, 0xffff0000, v85
v_cvt_pk_bf16_f32 v0, v0, v0
v_lshlrev_b32 v0, 16, v0
v_add_f32 v0, v0, v86
v_cvt_pk_bf16_f32 v0, v0, v0
v_lshlrev_b32 v0, 16, v0
v_mul_f32 v90, v0, v0
v_mov_b32 v91, 0x3d372713
v_fma_f32 v90, v90, v91, 1.0
v_mul_f32 v90, v90, v0
v_mul_f32 v90, 0x40135761, v90
v_exp_f32 v90, v90
s_nop 0
v_add_f32 v90, 1.0, v90
v_rcp_f32 v90, v90
s_nop 0
v_fma_f32 v90, v90, -2.0, 1.0
v_add_f32 v90, 1.0, v90
v_mul_f32 v90, 0.5, v90
v_mul_f32 v0, v0, v90
v_cvt_pk_bf16_f32 v1, v1, v1
v_lshlrev_b32 v1, 16, v1
v_add_f32 v1, v1, v87
v_cvt_pk_bf16_f32 v1, v1, v1
v_lshlrev_b32 v1, 16, v1
v_mul_f32 v90, v1, v1
v_mov_b32 v91, 0x3d372713
v_fma_f32 v90, v90, v91, 1.0
v_mul_f32 v90, v90, v1
v_mul_f32 v90, 0x40135761, v90
v_exp_f32 v90, v90
s_nop 0
v_add_f32 v90, 1.0, v90
v_rcp_f32 v90, v90
s_nop 0
v_fma_f32 v90, v90, -2.0, 1.0
v_add_f32 v90, 1.0, v90
v_mul_f32 v90, 0.5, v90
v_mul_f32 v1, v1, v90
v_cvt_pk_bf16_f32 v2, v2, v2
v_lshlrev_b32 v2, 16, v2
v_add_f32 v2, v2, v88
v_cvt_pk_bf16_f32 v2, v2, v2
v_lshlrev_b32 v2, 16, v2
v_mul_f32 v90, v2, v2
v_mov_b32 v91, 0x3d372713
v_fma_f32 v90, v90, v91, 1.0
v_mul_f32 v90, v90, v2
v_mul_f32 v90, 0x40135761, v90
v_exp_f32 v90, v90
s_nop 0
v_add_f32 v90, 1.0, v90
v_rcp_f32 v90, v90
s_nop 0
v_fma_f32 v90, v90, -2.0, 1.0
v_add_f32 v90, 1.0, v90
v_mul_f32 v90, 0.5, v90
v_mul_f32 v2, v2, v90
v_cvt_pk_bf16_f32 v3, v3, v3
v_lshlrev_b32 v3, 16, v3
v_add_f32 v3, v3, v89
v_cvt_pk_bf16_f32 v3, v3, v3
v_lshlrev_b32 v3, 16, v3
v_mul_f32 v90, v3, v3
v_mov_b32 v91, 0x3d372713
v_fma_f32 v90, v90, v91, 1.0
v_mul_f32 v90, v90, v3
v_mul_f32 v90, 0x40135761, v90
v_exp_f32 v90, v90
s_nop 0
v_add_f32 v90, 1.0, v90
v_rcp_f32 v90, v90
s_nop 0
v_fma_f32 v90, v90, -2.0, 1.0
v_add_f32 v90, 1.0, v90
v_mul_f32 v90, 0.5, v90
v_mul_f32 v3, v3, v90
v_cvt_pk_bf16_f32 v0, v0, v1
v_cvt_pk_bf16_f32 v1, v2, v3
v_cvt_pk_bf16_f32 v16, v16, v16
v_lshlrev_b32 v16, 16, v16
v_add_f32 v16, v16, v86
v_cvt_pk_bf16_f32 v16, v16, v16
v_lshlrev_b32 v16, 16, v16
v_mul_f32 v90, v16, v16
v_mov_b32 v91, 0x3d372713
v_fma_f32 v90, v90, v91, 1.0
v_mul_f32 v90, v90, v16
v_mul_f32 v90, 0x40135761, v90
v_exp_f32 v90, v90
s_nop 0
v_add_f32 v90, 1.0, v90
v_rcp_f32 v90, v90
s_nop 0
v_fma_f32 v90, v90, -2.0, 1.0
v_add_f32 v90, 1.0, v90
v_mul_f32 v90, 0.5, v90
v_mul_f32 v16, v16, v90
v_cvt_pk_bf16_f32 v17, v17, v17
v_lshlrev_b32 v17, 16, v17
v_add_f32 v17, v17, v87
v_cvt_pk_bf16_f32 v17, v17, v17
v_lshlrev_b32 v17, 16, v17
v_mul_f32 v90, v17, v17
v_mov_b32 v91, 0x3d372713
v_fma_f32 v90, v90, v91, 1.0
v_mul_f32 v90, v90, v17
v_mul_f32 v90, 0x40135761, v90
v_exp_f32 v90, v90
s_nop 0
v_add_f32 v90, 1.0, v90
v_rcp_f32 v90, v90
s_nop 0
v_fma_f32 v90, v90, -2.0, 1.0
v_add_f32 v90, 1.0, v90
v_mul_f32 v90, 0.5, v90
v_mul_f32 v17, v17, v90
v_cvt_pk_bf16_f32 v18, v18, v18
v_lshlrev_b32 v18, 16, v18
v_add_f32 v18, v18, v88
v_cvt_pk_bf16_f32 v18, v18, v18
v_lshlrev_b32 v18, 16, v18
v_mul_f32 v90, v18, v18
v_mov_b32 v91, 0x3d372713
v_fma_f32 v90, v90, v91, 1.0
v_mul_f32 v90, v90, v18
v_mul_f32 v90, 0x40135761, v90
v_exp_f32 v90, v90
s_nop 0
v_add_f32 v90, 1.0, v90
v_rcp_f32 v90, v90
s_nop 0
v_fma_f32 v90, v90, -2.0, 1.0
v_add_f32 v90, 1.0, v90
v_mul_f32 v90, 0.5, v90
v_mul_f32 v18, v18, v90
v_cvt_pk_bf16_f32 v19, v19, v19
v_lshlrev_b32 v19, 16, v19
v_add_f32 v19, v19, v89
v_cvt_pk_bf16_f32 v19, v19, v19
v_lshlrev_b32 v19, 16, v19
v_mul_f32 v90, v19, v19
v_mov_b32 v91, 0x3d372713
v_fma_f32 v90, v90, v91, 1.0
v_mul_f32 v90, v90, v19
v_mul_f32 v90, 0x40135761, v90
v_exp_f32 v90, v90
s_nop 0
v_add_f32 v90, 1.0, v90
v_rcp_f32 v90, v90
s_nop 0
v_fma_f32 v90, v90, -2.0, 1.0
v_add_f32 v90, 1.0, v90
v_mul_f32 v90, 0.5, v90
v_mul_f32 v19, v19, v90
v_cvt_pk_bf16_f32 v16, v16, v17
v_cvt_pk_bf16_f32 v17, v18, v19
v_cvt_pk_bf16_f32 v32, v32, v32
v_lshlrev_b32 v32, 16, v32
v_add_f32 v32, v32, v86
v_cvt_pk_bf16_f32 v32, v32, v32
v_lshlrev_b32 v32, 16, v32
v_mul_f32 v90, v32, v32
v_mov_b32 v91, 0x3d372713
v_fma_f32 v90, v90, v91, 1.0
v_mul_f32 v90, v90, v32
v_mul_f32 v90, 0x40135761, v90
v_exp_f32 v90, v90
s_nop 0
v_add_f32 v90, 1.0, v90
v_rcp_f32 v90, v90
s_nop 0
v_fma_f32 v90, v90, -2.0, 1.0
v_add_f32 v90, 1.0, v90
v_mul_f32 v90, 0.5, v90
v_mul_f32 v32, v32, v90
v_cvt_pk_bf16_f32 v33, v33, v33
v_lshlrev_b32 v33, 16, v33
v_add_f32 v33, v33, v87
v_cvt_pk_bf16_f32 v33, v33, v33
v_lshlrev_b32 v33, 16, v33
v_mul_f32 v90, v33, v33
v_mov_b32 v91, 0x3d372713
v_fma_f32 v90, v90, v91, 1.0
v_mul_f32 v90, v90, v33
v_mul_f32 v90, 0x40135761, v90
v_exp_f32 v90, v90
s_nop 0
v_add_f32 v90, 1.0, v90
v_rcp_f32 v90, v90
s_nop 0
v_fma_f32 v90, v90, -2.0, 1.0
v_add_f32 v90, 1.0, v90
v_mul_f32 v90, 0.5, v90
v_mul_f32 v33, v33, v90
v_cvt_pk_bf16_f32 v34, v34, v34
v_lshlrev_b32 v34, 16, v34
v_add_f32 v34, v34, v88
v_cvt_pk_bf16_f32 v34, v34, v34
v_lshlrev_b32 v34, 16, v34
v_mul_f32 v90, v34, v34
v_mov_b32 v91, 0x3d372713
v_fma_f32 v90, v90, v91, 1.0
v_mul_f32 v90, v90, v34
v_mul_f32 v90, 0x40135761, v90
v_exp_f32 v90, v90
s_nop 0
v_add_f32 v90, 1.0, v90
v_rcp_f32 v90, v90
s_nop 0
v_fma_f32 v90, v90, -2.0, 1.0
v_add_f32 v90, 1.0, v90
v_mul_f32 v90, 0.5, v90
v_mul_f32 v34, v34, v90
v_cvt_pk_bf16_f32 v35, v35, v35
v_lshlrev_b32 v35, 16, v35
v_add_f32 v35, v35, v89
v_cvt_pk_bf16_f32 v35, v35, v35
v_lshlrev_b32 v35, 16, v35
v_mul_f32 v90, v35, v35
v_mov_b32 v91, 0x3d372713
v_fma_f32 v90, v90, v91, 1.0
v_mul_f32 v90, v90, v35
v_mul_f32 v90, 0x40135761, v90
v_exp_f32 v90, v90
s_nop 0
v_add_f32 v90, 1.0, v90
v_rcp_f32 v90, v90
s_nop 0
v_fma_f32 v90, v90, -2.0, 1.0
v_add_f32 v90, 1.0, v90
v_mul_f32 v90, 0.5, v90
v_mul_f32 v35, v35, v90
v_cvt_pk_bf16_f32 v32, v32, v33
v_cvt_pk_bf16_f32 v33, v34, v35
v_cvt_pk_bf16_f32 v48, v48, v48
v_lshlrev_b32 v48, 16, v48
v_add_f32 v48, v48, v86
v_cvt_pk_bf16_f32 v48, v48, v48
v_lshlrev_b32 v48, 16, v48
v_mul_f32 v90, v48, v48
v_mov_b32 v91, 0x3d372713
v_fma_f32 v90, v90, v91, 1.0
v_mul_f32 v90, v90, v48
v_mul_f32 v90, 0x40135761, v90
v_exp_f32 v90, v90
s_nop 0
v_add_f32 v90, 1.0, v90
v_rcp_f32 v90, v90
s_nop 0
v_fma_f32 v90, v90, -2.0, 1.0
v_add_f32 v90, 1.0, v90
v_mul_f32 v90, 0.5, v90
v_mul_f32 v48, v48, v90
v_cvt_pk_bf16_f32 v49, v49, v49
v_lshlrev_b32 v49, 16, v49
v_add_f32 v49, v49, v87
v_cvt_pk_bf16_f32 v49, v49, v49
v_lshlrev_b32 v49, 16, v49
v_mul_f32 v90, v49, v49
v_mov_b32 v91, 0x3d372713
v_fma_f32 v90, v90, v91, 1.0
v_mul_f32 v90, v90, v49
v_mul_f32 v90, 0x40135761, v90
v_exp_f32 v90, v90
s_nop 0
v_add_f32 v90, 1.0, v90
v_rcp_f32 v90, v90
s_nop 0
v_fma_f32 v90, v90, -2.0, 1.0
v_add_f32 v90, 1.0, v90
v_mul_f32 v90, 0.5, v90
v_mul_f32 v49, v49, v90
v_cvt_pk_bf16_f32 v50, v50, v50
v_lshlrev_b32 v50, 16, v50
v_add_f32 v50, v50, v88
v_cvt_pk_bf16_f32 v50, v50, v50
v_lshlrev_b32 v50, 16, v50
v_mul_f32 v90, v50, v50
v_mov_b32 v91, 0x3d372713
v_fma_f32 v90, v90, v91, 1.0
v_mul_f32 v90, v90, v50
v_mul_f32 v90, 0x40135761, v90
v_exp_f32 v90, v90
s_nop 0
v_add_f32 v90, 1.0, v90
v_rcp_f32 v90, v90
s_nop 0
v_fma_f32 v90, v90, -2.0, 1.0
v_add_f32 v90, 1.0, v90
v_mul_f32 v90, 0.5, v90
v_mul_f32 v50, v50, v90
v_cvt_pk_bf16_f32 v51, v51, v51
v_lshlrev_b32 v51, 16, v51
v_add_f32 v51, v51, v89
v_cvt_pk_bf16_f32 v51, v51, v51
v_lshlrev_b32 v51, 16, v51
v_mul_f32 v90, v51, v51
v_mov_b32 v91, 0x3d372713
v_fma_f32 v90, v90, v91, 1.0
v_mul_f32 v90, v90, v51
v_mul_f32 v90, 0x40135761, v90
v_exp_f32 v90, v90
s_nop 0
v_add_f32 v90, 1.0, v90
v_rcp_f32 v90, v90
s_nop 0
v_fma_f32 v90, v90, -2.0, 1.0
v_add_f32 v90, 1.0, v90
v_mul_f32 v90, 0.5, v90
v_mul_f32 v51, v51, v90
v_cvt_pk_bf16_f32 v48, v48, v49
v_cvt_pk_bf16_f32 v49, v50, v51
s_add_u32 s23, s22, s27
buffer_store_dwordx2 v[0:1], v94, s[8:11], s23 offen
s_add_u32 s23, s23, 44032
buffer_store_dwordx2 v[16:17], v94, s[8:11], s23 offen
s_add_u32 s23, s23, 44032
buffer_store_dwordx2 v[32:33], v94, s[8:11], s23 offen
s_add_u32 s23, s23, 44032
buffer_store_dwordx2 v[48:49], v94, s[8:11], s23 offen
s_add_u32 s23, s23, 44032
Lskip0_mlp1_kernel:
s_add_u32 s22, s21, 1
s_cmp_ge_u32 s22, 86
s_cbranch_scc1 Lskip1_mlp1_kernel
s_add_u32 s22, s21, 1
s_lshl_b32 s22, s22, 5
v_lshlrev_b32 v95, 3, v97
buffer_load_dwordx2 v[84:85], v95, s[12:15], s22 offen
s_waitcnt vmcnt(0)
v_lshlrev_b32 v86, 16, v84
v_and_b32 v87, 0xffff0000, v84
v_lshlrev_b32 v88, 16, v85
v_and_b32 v89, 0xffff0000, v85
v_cvt_pk_bf16_f32 v4, v4, v4
v_lshlrev_b32 v4, 16, v4
v_add_f32 v4, v4, v86
v_cvt_pk_bf16_f32 v4, v4, v4
v_lshlrev_b32 v4, 16, v4
v_mul_f32 v90, v4, v4
v_mov_b32 v91, 0x3d372713
v_fma_f32 v90, v90, v91, 1.0
v_mul_f32 v90, v90, v4
v_mul_f32 v90, 0x40135761, v90
v_exp_f32 v90, v90
s_nop 0
v_add_f32 v90, 1.0, v90
v_rcp_f32 v90, v90
s_nop 0
v_fma_f32 v90, v90, -2.0, 1.0
v_add_f32 v90, 1.0, v90
v_mul_f32 v90, 0.5, v90
v_mul_f32 v4, v4, v90
v_cvt_pk_bf16_f32 v5, v5, v5
v_lshlrev_b32 v5, 16, v5
v_add_f32 v5, v5, v87
v_cvt_pk_bf16_f32 v5, v5, v5
v_lshlrev_b32 v5, 16, v5
v_mul_f32 v90, v5, v5
v_mov_b32 v91, 0x3d372713
v_fma_f32 v90, v90, v91, 1.0
v_mul_f32 v90, v90, v5
v_mul_f32 v90, 0x40135761, v90
v_exp_f32 v90, v90
s_nop 0
v_add_f32 v90, 1.0, v90
v_rcp_f32 v90, v90
s_nop 0
v_fma_f32 v90, v90, -2.0, 1.0
v_add_f32 v90, 1.0, v90
v_mul_f32 v90, 0.5, v90
v_mul_f32 v5, v5, v90
v_cvt_pk_bf16_f32 v6, v6, v6
v_lshlrev_b32 v6, 16, v6
v_add_f32 v6, v6, v88
v_cvt_pk_bf16_f32 v6, v6, v6
v_lshlrev_b32 v6, 16, v6
v_mul_f32 v90, v6, v6
v_mov_b32 v91, 0x3d372713
v_fma_f32 v90, v90, v91, 1.0
v_mul_f32 v90, v90, v6
v_mul_f32 v90, 0x40135761, v90
v_exp_f32 v90, v90
s_nop 0
v_add_f32 v90, 1.0, v90
v_rcp_f32 v90, v90
s_nop 0
v_fma_f32 v90, v90, -2.0, 1.0
v_add_f32 v90, 1.0, v90
v_mul_f32 v90, 0.5, v90
v_mul_f32 v6, v6, v90
v_cvt_pk_bf16_f32 v7, v7, v7
v_lshlrev_b32 v7, 16, v7
v_add_f32 v7, v7, v89
v_cvt_pk_bf16_f32 v7, v7, v7
v_lshlrev_b32 v7, 16, v7
v_mul_f32 v90, v7, v7
v_mov_b32 v91, 0x3d372713
v_fma_f32 v90, v90, v91, 1.0
v_mul_f32 v90, v90, v7
v_mul_f32 v90, 0x40135761, v90
v_exp_f32 v90, v90
s_nop 0
v_add_f32 v90, 1.0, v90
v_rcp_f32 v90, v90
s_nop 0
v_fma_f32 v90, v90, -2.0, 1.0
v_add_f32 v90, 1.0, v90
v_mul_f32 v90, 0.5, v90
v_mul_f32 v7, v7, v90
v_cvt_pk_bf16_f32 v4, v4, v5
v_cvt_pk_bf16_f32 v5, v6, v7
v_cvt_pk_bf16_f32 v20, v20, v20
v_lshlrev_b32 v20, 16, v20
v_add_f32 v20, v20, v86
v_cvt_pk_bf16_f32 v20, v20, v20
v_lshlrev_b32 v20, 16, v20
v_mul_f32 v90, v20, v20
v_mov_b32 v91, 0x3d372713
v_fma_f32 v90, v90, v91, 1.0
v_mul_f32 v90, v90, v20
v_mul_f32 v90, 0x40135761, v90
v_exp_f32 v90, v90
s_nop 0
v_add_f32 v90, 1.0, v90
v_rcp_f32 v90, v90
s_nop 0
v_fma_f32 v90, v90, -2.0, 1.0
v_add_f32 v90, 1.0, v90
v_mul_f32 v90, 0.5, v90
v_mul_f32 v20, v20, v90
v_cvt_pk_bf16_f32 v21, v21, v21
v_lshlrev_b32 v21, 16, v21
v_add_f32 v21, v21, v87
v_cvt_pk_bf16_f32 v21, v21, v21
v_lshlrev_b32 v21, 16, v21
v_mul_f32 v90, v21, v21
v_mov_b32 v91, 0x3d372713
v_fma_f32 v90, v90, v91, 1.0
v_mul_f32 v90, v90, v21
v_mul_f32 v90, 0x40135761, v90
v_exp_f32 v90, v90
s_nop 0
v_add_f32 v90, 1.0, v90
v_rcp_f32 v90, v90
s_nop 0
v_fma_f32 v90, v90, -2.0, 1.0
v_add_f32 v90, 1.0, v90
v_mul_f32 v90, 0.5, v90
v_mul_f32 v21, v21, v90
v_cvt_pk_bf16_f32 v22, v22, v22
v_lshlrev_b32 v22, 16, v22
v_add_f32 v22, v22, v88
v_cvt_pk_bf16_f32 v22, v22, v22
v_lshlrev_b32 v22, 16, v22
v_mul_f32 v90, v22, v22
v_mov_b32 v91, 0x3d372713
v_fma_f32 v90, v90, v91, 1.0
v_mul_f32 v90, v90, v22
v_mul_f32 v90, 0x40135761, v90
v_exp_f32 v90, v90
s_nop 0
v_add_f32 v90, 1.0, v90
v_rcp_f32 v90, v90
s_nop 0
v_fma_f32 v90, v90, -2.0, 1.0
v_add_f32 v90, 1.0, v90
v_mul_f32 v90, 0.5, v90
v_mul_f32 v22, v22, v90
v_cvt_pk_bf16_f32 v23, v23, v23
v_lshlrev_b32 v23, 16, v23
v_add_f32 v23, v23, v89
v_cvt_pk_bf16_f32 v23, v23, v23
v_lshlrev_b32 v23, 16, v23
v_mul_f32 v90, v23, v23
v_mov_b32 v91, 0x3d372713
v_fma_f32 v90, v90, v91, 1.0
v_mul_f32 v90, v90, v23
v_mul_f32 v90, 0x40135761, v90
v_exp_f32 v90, v90
s_nop 0
v_add_f32 v90, 1.0, v90
v_rcp_f32 v90, v90
s_nop 0
v_fma_f32 v90, v90, -2.0, 1.0
v_add_f32 v90, 1.0, v90
v_mul_f32 v90, 0.5, v90
v_mul_f32 v23, v23, v90
v_cvt_pk_bf16_f32 v20, v20, v21
v_cvt_pk_bf16_f32 v21, v22, v23
v_cvt_pk_bf16_f32 v36, v36, v36
v_lshlrev_b32 v36, 16, v36
v_add_f32 v36, v36, v86
v_cvt_pk_bf16_f32 v36, v36, v36
v_lshlrev_b32 v36, 16, v36
v_mul_f32 v90, v36, v36
v_mov_b32 v91, 0x3d372713
v_fma_f32 v90, v90, v91, 1.0
v_mul_f32 v90, v90, v36
v_mul_f32 v90, 0x40135761, v90
v_exp_f32 v90, v90
s_nop 0
v_add_f32 v90, 1.0, v90
v_rcp_f32 v90, v90
s_nop 0
v_fma_f32 v90, v90, -2.0, 1.0
v_add_f32 v90, 1.0, v90
v_mul_f32 v90, 0.5, v90
v_mul_f32 v36, v36, v90
v_cvt_pk_bf16_f32 v37, v37, v37
v_lshlrev_b32 v37, 16, v37
v_add_f32 v37, v37, v87
v_cvt_pk_bf16_f32 v37, v37, v37
v_lshlrev_b32 v37, 16, v37
v_mul_f32 v90, v37, v37
v_mov_b32 v91, 0x3d372713
v_fma_f32 v90, v90, v91, 1.0
v_mul_f32 v90, v90, v37
v_mul_f32 v90, 0x40135761, v90
v_exp_f32 v90, v90
s_nop 0
v_add_f32 v90, 1.0, v90
v_rcp_f32 v90, v90
s_nop 0
v_fma_f32 v90, v90, -2.0, 1.0
v_add_f32 v90, 1.0, v90
v_mul_f32 v90, 0.5, v90
v_mul_f32 v37, v37, v90
v_cvt_pk_bf16_f32 v38, v38, v38
v_lshlrev_b32 v38, 16, v38
v_add_f32 v38, v38, v88
v_cvt_pk_bf16_f32 v38, v38, v38
v_lshlrev_b32 v38, 16, v38
v_mul_f32 v90, v38, v38
v_mov_b32 v91, 0x3d372713
v_fma_f32 v90, v90, v91, 1.0
v_mul_f32 v90, v90, v38
v_mul_f32 v90, 0x40135761, v90
v_exp_f32 v90, v90
s_nop 0
v_add_f32 v90, 1.0, v90
v_rcp_f32 v90, v90
s_nop 0
v_fma_f32 v90, v90, -2.0, 1.0
v_add_f32 v90, 1.0, v90
v_mul_f32 v90, 0.5, v90
v_mul_f32 v38, v38, v90
v_cvt_pk_bf16_f32 v39, v39, v39
v_lshlrev_b32 v39, 16, v39
v_add_f32 v39, v39, v89
v_cvt_pk_bf16_f32 v39, v39, v39
v_lshlrev_b32 v39, 16, v39
v_mul_f32 v90, v39, v39
v_mov_b32 v91, 0x3d372713
v_fma_f32 v90, v90, v91, 1.0
v_mul_f32 v90, v90, v39
v_mul_f32 v90, 0x40135761, v90
v_exp_f32 v90, v90
s_nop 0
v_add_f32 v90, 1.0, v90
v_rcp_f32 v90, v90
s_nop 0
v_fma_f32 v90, v90, -2.0, 1.0
v_add_f32 v90, 1.0, v90
v_mul_f32 v90, 0.5, v90
v_mul_f32 v39, v39, v90
v_cvt_pk_bf16_f32 v36, v36, v37
v_cvt_pk_bf16_f32 v37, v38, v39
v_cvt_pk_bf16_f32 v52, v52, v52
v_lshlrev_b32 v52, 16, v52
v_add_f32 v52, v52, v86
v_cvt_pk_bf16_f32 v52, v52, v52
v_lshlrev_b32 v52, 16, v52
v_mul_f32 v90, v52, v52
v_mov_b32 v91, 0x3d372713
v_fma_f32 v90, v90, v91, 1.0
v_mul_f32 v90, v90, v52
v_mul_f32 v90, 0x40135761, v90
v_exp_f32 v90, v90
s_nop 0
v_add_f32 v90, 1.0, v90
v_rcp_f32 v90, v90
s_nop 0
v_fma_f32 v90, v90, -2.0, 1.0
v_add_f32 v90, 1.0, v90
v_mul_f32 v90, 0.5, v90
v_mul_f32 v52, v52, v90
v_cvt_pk_bf16_f32 v53, v53, v53
v_lshlrev_b32 v53, 16, v53
v_add_f32 v53, v53, v87
v_cvt_pk_bf16_f32 v53, v53, v53
v_lshlrev_b32 v53, 16, v53
v_mul_f32 v90, v53, v53
v_mov_b32 v91, 0x3d372713
v_fma_f32 v90, v90, v91, 1.0
v_mul_f32 v90, v90, v53
v_mul_f32 v90, 0x40135761, v90
v_exp_f32 v90, v90
s_nop 0
v_add_f32 v90, 1.0, v90
v_rcp_f32 v90, v90
s_nop 0
v_fma_f32 v90, v90, -2.0, 1.0
v_add_f32 v90, 1.0, v90
v_mul_f32 v90, 0.5, v90
v_mul_f32 v53, v53, v90
v_cvt_pk_bf16_f32 v54, v54, v54
v_lshlrev_b32 v54, 16, v54
v_add_f32 v54, v54, v88
v_cvt_pk_bf16_f32 v54, v54, v54
v_lshlrev_b32 v54, 16, v54
v_mul_f32 v90, v54, v54
v_mov_b32 v91, 0x3d372713
v_fma_f32 v90, v90, v91, 1.0
v_mul_f32 v90, v90, v54
v_mul_f32 v90, 0x40135761, v90
v_exp_f32 v90, v90
s_nop 0
v_add_f32 v90, 1.0, v90
v_rcp_f32 v90, v90
s_nop 0
v_fma_f32 v90, v90, -2.0, 1.0
v_add_f32 v90, 1.0, v90
v_mul_f32 v90, 0.5, v90
v_mul_f32 v54, v54, v90
v_cvt_pk_bf16_f32 v55, v55, v55
v_lshlrev_b32 v55, 16, v55
v_add_f32 v55, v55, v89
v_cvt_pk_bf16_f32 v55, v55, v55
v_lshlrev_b32 v55, 16, v55
v_mul_f32 v90, v55, v55
v_mov_b32 v91, 0x3d372713
v_fma_f32 v90, v90, v91, 1.0
v_mul_f32 v90, v90, v55
v_mul_f32 v90, 0x40135761, v90
v_exp_f32 v90, v90
s_nop 0
v_add_f32 v90, 1.0, v90
v_rcp_f32 v90, v90
s_nop 0
v_fma_f32 v90, v90, -2.0, 1.0
v_add_f32 v90, 1.0, v90
v_mul_f32 v90, 0.5, v90
v_mul_f32 v55, v55, v90
v_cvt_pk_bf16_f32 v52, v52, v53
v_cvt_pk_bf16_f32 v53, v54, v55
s_add_u32 s23, s22, s27
buffer_store_dwordx2 v[4:5], v94, s[8:11], s23 offen
s_add_u32 s23, s23, 44032
buffer_store_dwordx2 v[20:21], v94, s[8:11], s23 offen
s_add_u32 s23, s23, 44032
buffer_store_dwordx2 v[36:37], v94, s[8:11], s23 offen
s_add_u32 s23, s23, 44032
buffer_store_dwordx2 v[52:53], v94, s[8:11], s23 offen
s_add_u32 s23, s23, 44032
Lskip1_mlp1_kernel:
s_add_u32 s22, s21, 2
s_cmp_ge_u32 s22, 86
s_cbranch_scc1 Lskip2_mlp1_kernel
s_add_u32 s22, s21, 2
s_lshl_b32 s22, s22, 5
v_lshlrev_b32 v95, 3, v97
buffer_load_dwordx2 v[84:85], v95, s[12:15], s22 offen
s_waitcnt vmcnt(0)
v_lshlrev_b32 v86, 16, v84
v_and_b32 v87, 0xffff0000, v84
v_lshlrev_b32 v88, 16, v85
v_and_b32 v89, 0xffff0000, v85
v_cvt_pk_bf16_f32 v8, v8, v8
v_lshlrev_b32 v8, 16, v8
v_add_f32 v8, v8, v86
v_cvt_pk_bf16_f32 v8, v8, v8
v_lshlrev_b32 v8, 16, v8
v_mul_f32 v90, v8, v8
v_mov_b32 v91, 0x3d372713
v_fma_f32 v90, v90, v91, 1.0
v_mul_f32 v90, v90, v8
v_mul_f32 v90, 0x40135761, v90
v_exp_f32 v90, v90
s_nop 0
v_add_f32 v90, 1.0, v90
v_rcp_f32 v90, v90
s_nop 0
v_fma_f32 v90, v90, -2.0, 1.0
v_add_f32 v90, 1.0, v90
v_mul_f32 v90, 0.5, v90
v_mul_f32 v8, v8, v90
v_cvt_pk_bf16_f32 v9, v9, v9
v_lshlrev_b32 v9, 16, v9
v_add_f32 v9, v9, v87
v_cvt_pk_bf16_f32 v9, v9, v9
v_lshlrev_b32 v9, 16, v9
v_mul_f32 v90, v9, v9
v_mov_b32 v91, 0x3d372713
v_fma_f32 v90, v90, v91, 1.0
v_mul_f32 v90, v90, v9
v_mul_f32 v90, 0x40135761, v90
v_exp_f32 v90, v90
s_nop 0
v_add_f32 v90, 1.0, v90
v_rcp_f32 v90, v90
s_nop 0
v_fma_f32 v90, v90, -2.0, 1.0
v_add_f32 v90, 1.0, v90
v_mul_f32 v90, 0.5, v90
v_mul_f32 v9, v9, v90
v_cvt_pk_bf16_f32 v10, v10, v10
v_lshlrev_b32 v10, 16, v10
v_add_f32 v10, v10, v88
v_cvt_pk_bf16_f32 v10, v10, v10
v_lshlrev_b32 v10, 16, v10
v_mul_f32 v90, v10, v10
v_mov_b32 v91, 0x3d372713
v_fma_f32 v90, v90, v91, 1.0
v_mul_f32 v90, v90, v10
v_mul_f32 v90, 0x40135761, v90
v_exp_f32 v90, v90
s_nop 0
v_add_f32 v90, 1.0, v90
v_rcp_f32 v90, v90
s_nop 0
v_fma_f32 v90, v90, -2.0, 1.0
v_add_f32 v90, 1.0, v90
v_mul_f32 v90, 0.5, v90
v_mul_f32 v10, v10, v90
v_cvt_pk_bf16_f32 v11, v11, v11
v_lshlrev_b32 v11, 16, v11
v_add_f32 v11, v11, v89
v_cvt_pk_bf16_f32 v11, v11, v11
v_lshlrev_b32 v11, 16, v11
v_mul_f32 v90, v11, v11
v_mov_b32 v91, 0x3d372713
v_fma_f32 v90, v90, v91, 1.0
v_mul_f32 v90, v90, v11
v_mul_f32 v90, 0x40135761, v90
v_exp_f32 v90, v90
s_nop 0
v_add_f32 v90, 1.0, v90
v_rcp_f32 v90, v90
s_nop 0
v_fma_f32 v90, v90, -2.0, 1.0
v_add_f32 v90, 1.0, v90
v_mul_f32 v90, 0.5, v90
v_mul_f32 v11, v11, v90
v_cvt_pk_bf16_f32 v8, v8, v9
v_cvt_pk_bf16_f32 v9, v10, v11
v_cvt_pk_bf16_f32 v24, v24, v24
v_lshlrev_b32 v24, 16, v24
v_add_f32 v24, v24, v86
v_cvt_pk_bf16_f32 v24, v24, v24
v_lshlrev_b32 v24, 16, v24
v_mul_f32 v90, v24, v24
v_mov_b32 v91, 0x3d372713
v_fma_f32 v90, v90, v91, 1.0
v_mul_f32 v90, v90, v24
v_mul_f32 v90, 0x40135761, v90
v_exp_f32 v90, v90
s_nop 0
v_add_f32 v90, 1.0, v90
v_rcp_f32 v90, v90
s_nop 0
v_fma_f32 v90, v90, -2.0, 1.0
v_add_f32 v90, 1.0, v90
v_mul_f32 v90, 0.5, v90
v_mul_f32 v24, v24, v90
v_cvt_pk_bf16_f32 v25, v25, v25
v_lshlrev_b32 v25, 16, v25
v_add_f32 v25, v25, v87
v_cvt_pk_bf16_f32 v25, v25, v25
v_lshlrev_b32 v25, 16, v25
v_mul_f32 v90, v25, v25
v_mov_b32 v91, 0x3d372713
v_fma_f32 v90, v90, v91, 1.0
v_mul_f32 v90, v90, v25
v_mul_f32 v90, 0x40135761, v90
v_exp_f32 v90, v90
s_nop 0
v_add_f32 v90, 1.0, v90
v_rcp_f32 v90, v90
s_nop 0
v_fma_f32 v90, v90, -2.0, 1.0
v_add_f32 v90, 1.0, v90
v_mul_f32 v90, 0.5, v90
v_mul_f32 v25, v25, v90
v_cvt_pk_bf16_f32 v26, v26, v26
v_lshlrev_b32 v26, 16, v26
v_add_f32 v26, v26, v88
v_cvt_pk_bf16_f32 v26, v26, v26
v_lshlrev_b32 v26, 16, v26
v_mul_f32 v90, v26, v26
v_mov_b32 v91, 0x3d372713
v_fma_f32 v90, v90, v91, 1.0
v_mul_f32 v90, v90, v26
v_mul_f32 v90, 0x40135761, v90
v_exp_f32 v90, v90
s_nop 0
v_add_f32 v90, 1.0, v90
v_rcp_f32 v90, v90
s_nop 0
v_fma_f32 v90, v90, -2.0, 1.0
v_add_f32 v90, 1.0, v90
v_mul_f32 v90, 0.5, v90
v_mul_f32 v26, v26, v90
v_cvt_pk_bf16_f32 v27, v27, v27
v_lshlrev_b32 v27, 16, v27
v_add_f32 v27, v27, v89
v_cvt_pk_bf16_f32 v27, v27, v27
v_lshlrev_b32 v27, 16, v27
v_mul_f32 v90, v27, v27
v_mov_b32 v91, 0x3d372713
v_fma_f32 v90, v90, v91, 1.0
v_mul_f32 v90, v90, v27
v_mul_f32 v90, 0x40135761, v90
v_exp_f32 v90, v90
s_nop 0
v_add_f32 v90, 1.0, v90
v_rcp_f32 v90, v90
s_nop 0
v_fma_f32 v90, v90, -2.0, 1.0
v_add_f32 v90, 1.0, v90
v_mul_f32 v90, 0.5, v90
v_mul_f32 v27, v27, v90
v_cvt_pk_bf16_f32 v24, v24, v25
v_cvt_pk_bf16_f32 v25, v26, v27
v_cvt_pk_bf16_f32 v40, v40, v40
v_lshlrev_b32 v40, 16, v40
v_add_f32 v40, v40, v86
v_cvt_pk_bf16_f32 v40, v40, v40
v_lshlrev_b32 v40, 16, v40
v_mul_f32 v90, v40, v40
v_mov_b32 v91, 0x3d372713
v_fma_f32 v90, v90, v91, 1.0
v_mul_f32 v90, v90, v40
v_mul_f32 v90, 0x40135761, v90
v_exp_f32 v90, v90
s_nop 0
v_add_f32 v90, 1.0, v90
v_rcp_f32 v90, v90
s_nop 0
v_fma_f32 v90, v90, -2.0, 1.0
v_add_f32 v90, 1.0, v90
v_mul_f32 v90, 0.5, v90
v_mul_f32 v40, v40, v90
v_cvt_pk_bf16_f32 v41, v41, v41
v_lshlrev_b32 v41, 16, v41
v_add_f32 v41, v41, v87
v_cvt_pk_bf16_f32 v41, v41, v41
v_lshlrev_b32 v41, 16, v41
v_mul_f32 v90, v41, v41
v_mov_b32 v91, 0x3d372713
v_fma_f32 v90, v90, v91, 1.0
v_mul_f32 v90, v90, v41
v_mul_f32 v90, 0x40135761, v90
v_exp_f32 v90, v90
s_nop 0
v_add_f32 v90, 1.0, v90
v_rcp_f32 v90, v90
s_nop 0
v_fma_f32 v90, v90, -2.0, 1.0
v_add_f32 v90, 1.0, v90
v_mul_f32 v90, 0.5, v90
v_mul_f32 v41, v41, v90
v_cvt_pk_bf16_f32 v42, v42, v42
v_lshlrev_b32 v42, 16, v42
v_add_f32 v42, v42, v88
v_cvt_pk_bf16_f32 v42, v42, v42
v_lshlrev_b32 v42, 16, v42
v_mul_f32 v90, v42, v42
v_mov_b32 v91, 0x3d372713
v_fma_f32 v90, v90, v91, 1.0
v_mul_f32 v90, v90, v42
v_mul_f32 v90, 0x40135761, v90
v_exp_f32 v90, v90
s_nop 0
v_add_f32 v90, 1.0, v90
v_rcp_f32 v90, v90
s_nop 0
v_fma_f32 v90, v90, -2.0, 1.0
v_add_f32 v90, 1.0, v90
v_mul_f32 v90, 0.5, v90
v_mul_f32 v42, v42, v90
v_cvt_pk_bf16_f32 v43, v43, v43
v_lshlrev_b32 v43, 16, v43
v_add_f32 v43, v43, v89
v_cvt_pk_bf16_f32 v43, v43, v43
v_lshlrev_b32 v43, 16, v43
v_mul_f32 v90, v43, v43
v_mov_b32 v91, 0x3d372713
v_fma_f32 v90, v90, v91, 1.0
v_mul_f32 v90, v90, v43
v_mul_f32 v90, 0x40135761, v90
v_exp_f32 v90, v90
s_nop 0
v_add_f32 v90, 1.0, v90
v_rcp_f32 v90, v90
s_nop 0
v_fma_f32 v90, v90, -2.0, 1.0
v_add_f32 v90, 1.0, v90
v_mul_f32 v90, 0.5, v90
v_mul_f32 v43, v43, v90
v_cvt_pk_bf16_f32 v40, v40, v41
v_cvt_pk_bf16_f32 v41, v42, v43
v_cvt_pk_bf16_f32 v56, v56, v56
v_lshlrev_b32 v56, 16, v56
v_add_f32 v56, v56, v86
v_cvt_pk_bf16_f32 v56, v56, v56
v_lshlrev_b32 v56, 16, v56
v_mul_f32 v90, v56, v56
v_mov_b32 v91, 0x3d372713
v_fma_f32 v90, v90, v91, 1.0
v_mul_f32 v90, v90, v56
v_mul_f32 v90, 0x40135761, v90
v_exp_f32 v90, v90
s_nop 0
v_add_f32 v90, 1.0, v90
v_rcp_f32 v90, v90
s_nop 0
v_fma_f32 v90, v90, -2.0, 1.0
v_add_f32 v90, 1.0, v90
v_mul_f32 v90, 0.5, v90
v_mul_f32 v56, v56, v90
v_cvt_pk_bf16_f32 v57, v57, v57
v_lshlrev_b32 v57, 16, v57
v_add_f32 v57, v57, v87
v_cvt_pk_bf16_f32 v57, v57, v57
v_lshlrev_b32 v57, 16, v57
v_mul_f32 v90, v57, v57
v_mov_b32 v91, 0x3d372713
v_fma_f32 v90, v90, v91, 1.0
v_mul_f32 v90, v90, v57
v_mul_f32 v90, 0x40135761, v90
v_exp_f32 v90, v90
s_nop 0
v_add_f32 v90, 1.0, v90
v_rcp_f32 v90, v90
s_nop 0
v_fma_f32 v90, v90, -2.0, 1.0
v_add_f32 v90, 1.0, v90
v_mul_f32 v90, 0.5, v90
v_mul_f32 v57, v57, v90
v_cvt_pk_bf16_f32 v58, v58, v58
v_lshlrev_b32 v58, 16, v58
v_add_f32 v58, v58, v88
v_cvt_pk_bf16_f32 v58, v58, v58
v_lshlrev_b32 v58, 16, v58
v_mul_f32 v90, v58, v58
v_mov_b32 v91, 0x3d372713
v_fma_f32 v90, v90, v91, 1.0
v_mul_f32 v90, v90, v58
v_mul_f32 v90, 0x40135761, v90
v_exp_f32 v90, v90
s_nop 0
v_add_f32 v90, 1.0, v90
v_rcp_f32 v90, v90
s_nop 0
v_fma_f32 v90, v90, -2.0, 1.0
v_add_f32 v90, 1.0, v90
v_mul_f32 v90, 0.5, v90
v_mul_f32 v58, v58, v90
v_cvt_pk_bf16_f32 v59, v59, v59
v_lshlrev_b32 v59, 16, v59
v_add_f32 v59, v59, v89
v_cvt_pk_bf16_f32 v59, v59, v59
v_lshlrev_b32 v59, 16, v59
v_mul_f32 v90, v59, v59
v_mov_b32 v91, 0x3d372713
v_fma_f32 v90, v90, v91, 1.0
v_mul_f32 v90, v90, v59
v_mul_f32 v90, 0x40135761, v90
v_exp_f32 v90, v90
s_nop 0
v_add_f32 v90, 1.0, v90
v_rcp_f32 v90, v90
s_nop 0
v_fma_f32 v90, v90, -2.0, 1.0
v_add_f32 v90, 1.0, v90
v_mul_f32 v90, 0.5, v90
v_mul_f32 v59, v59, v90
v_cvt_pk_bf16_f32 v56, v56, v57
v_cvt_pk_bf16_f32 v57, v58, v59
s_add_u32 s23, s22, s27
buffer_store_dwordx2 v[8:9], v94, s[8:11], s23 offen
s_add_u32 s23, s23, 44032
buffer_store_dwordx2 v[24:25], v94, s[8:11], s23 offen
s_add_u32 s23, s23, 44032
buffer_store_dwordx2 v[40:41], v94, s[8:11], s23 offen
s_add_u32 s23, s23, 44032
buffer_store_dwordx2 v[56:57], v94, s[8:11], s23 offen
s_add_u32 s23, s23, 44032
Lskip2_mlp1_kernel:
s_add_u32 s22, s21, 3
s_cmp_ge_u32 s22, 86
s_cbranch_scc1 Lskip3_mlp1_kernel
s_add_u32 s22, s21, 3
s_lshl_b32 s22, s22, 5
v_lshlrev_b32 v95, 3, v97
buffer_load_dwordx2 v[84:85], v95, s[12:15], s22 offen
s_waitcnt vmcnt(0)
v_lshlrev_b32 v86, 16, v84
v_and_b32 v87, 0xffff0000, v84
v_lshlrev_b32 v88, 16, v85
v_and_b32 v89, 0xffff0000, v85
v_cvt_pk_bf16_f32 v12, v12, v12
v_lshlrev_b32 v12, 16, v12
v_add_f32 v12, v12, v86
v_cvt_pk_bf16_f32 v12, v12, v12
v_lshlrev_b32 v12, 16, v12
v_mul_f32 v90, v12, v12
v_mov_b32 v91, 0x3d372713
v_fma_f32 v90, v90, v91, 1.0
v_mul_f32 v90, v90, v12
v_mul_f32 v90, 0x40135761, v90
v_exp_f32 v90, v90
s_nop 0
v_add_f32 v90, 1.0, v90
v_rcp_f32 v90, v90
s_nop 0
v_fma_f32 v90, v90, -2.0, 1.0
v_add_f32 v90, 1.0, v90
v_mul_f32 v90, 0.5, v90
v_mul_f32 v12, v12, v90
v_cvt_pk_bf16_f32 v13, v13, v13
v_lshlrev_b32 v13, 16, v13
v_add_f32 v13, v13, v87
v_cvt_pk_bf16_f32 v13, v13, v13
v_lshlrev_b32 v13, 16, v13
v_mul_f32 v90, v13, v13
v_mov_b32 v91, 0x3d372713
v_fma_f32 v90, v90, v91, 1.0
v_mul_f32 v90, v90, v13
v_mul_f32 v90, 0x40135761, v90
v_exp_f32 v90, v90
s_nop 0
v_add_f32 v90, 1.0, v90
v_rcp_f32 v90, v90
s_nop 0
v_fma_f32 v90, v90, -2.0, 1.0
v_add_f32 v90, 1.0, v90
v_mul_f32 v90, 0.5, v90
v_mul_f32 v13, v13, v90
v_cvt_pk_bf16_f32 v14, v14, v14
v_lshlrev_b32 v14, 16, v14
v_add_f32 v14, v14, v88
v_cvt_pk_bf16_f32 v14, v14, v14
v_lshlrev_b32 v14, 16, v14
v_mul_f32 v90, v14, v14
v_mov_b32 v91, 0x3d372713
v_fma_f32 v90, v90, v91, 1.0
v_mul_f32 v90, v90, v14
v_mul_f32 v90, 0x40135761, v90
v_exp_f32 v90, v90
s_nop 0
v_add_f32 v90, 1.0, v90
v_rcp_f32 v90, v90
s_nop 0
v_fma_f32 v90, v90, -2.0, 1.0
v_add_f32 v90, 1.0, v90
v_mul_f32 v90, 0.5, v90
v_mul_f32 v14, v14, v90
v_cvt_pk_bf16_f32 v15, v15, v15
v_lshlrev_b32 v15, 16, v15
v_add_f32 v15, v15, v89
v_cvt_pk_bf16_f32 v15, v15, v15
v_lshlrev_b32 v15, 16, v15
v_mul_f32 v90, v15, v15
v_mov_b32 v91, 0x3d372713
v_fma_f32 v90, v90, v91, 1.0
v_mul_f32 v90, v90, v15
v_mul_f32 v90, 0x40135761, v90
v_exp_f32 v90, v90
s_nop 0
v_add_f32 v90, 1.0, v90
v_rcp_f32 v90, v90
s_nop 0
v_fma_f32 v90, v90, -2.0, 1.0
v_add_f32 v90, 1.0, v90
v_mul_f32 v90, 0.5, v90
v_mul_f32 v15, v15, v90
v_cvt_pk_bf16_f32 v12, v12, v13
v_cvt_pk_bf16_f32 v13, v14, v15
v_cvt_pk_bf16_f32 v28, v28, v28
v_lshlrev_b32 v28, 16, v28
v_add_f32 v28, v28, v86
v_cvt_pk_bf16_f32 v28, v28, v28
v_lshlrev_b32 v28, 16, v28
v_mul_f32 v90, v28, v28
v_mov_b32 v91, 0x3d372713
v_fma_f32 v90, v90, v91, 1.0
v_mul_f32 v90, v90, v28
v_mul_f32 v90, 0x40135761, v90
v_exp_f32 v90, v90
s_nop 0
v_add_f32 v90, 1.0, v90
v_rcp_f32 v90, v90
s_nop 0
v_fma_f32 v90, v90, -2.0, 1.0
v_add_f32 v90, 1.0, v90
v_mul_f32 v90, 0.5, v90
v_mul_f32 v28, v28, v90
v_cvt_pk_bf16_f32 v29, v29, v29
v_lshlrev_b32 v29, 16, v29
v_add_f32 v29, v29, v87
v_cvt_pk_bf16_f32 v29, v29, v29
v_lshlrev_b32 v29, 16, v29
v_mul_f32 v90, v29, v29
v_mov_b32 v91, 0x3d372713
v_fma_f32 v90, v90, v91, 1.0
v_mul_f32 v90, v90, v29
v_mul_f32 v90, 0x40135761, v90
v_exp_f32 v90, v90
s_nop 0
v_add_f32 v90, 1.0, v90
v_rcp_f32 v90, v90
s_nop 0
v_fma_f32 v90, v90, -2.0, 1.0
v_add_f32 v90, 1.0, v90
v_mul_f32 v90, 0.5, v90
v_mul_f32 v29, v29, v90
v_cvt_pk_bf16_f32 v30, v30, v30
v_lshlrev_b32 v30, 16, v30
v_add_f32 v30, v30, v88
v_cvt_pk_bf16_f32 v30, v30, v30
v_lshlrev_b32 v30, 16, v30
v_mul_f32 v90, v30, v30
v_mov_b32 v91, 0x3d372713
v_fma_f32 v90, v90, v91, 1.0
v_mul_f32 v90, v90, v30
v_mul_f32 v90, 0x40135761, v90
v_exp_f32 v90, v90
s_nop 0
v_add_f32 v90, 1.0, v90
v_rcp_f32 v90, v90
s_nop 0
v_fma_f32 v90, v90, -2.0, 1.0
v_add_f32 v90, 1.0, v90
v_mul_f32 v90, 0.5, v90
v_mul_f32 v30, v30, v90
v_cvt_pk_bf16_f32 v31, v31, v31
v_lshlrev_b32 v31, 16, v31
v_add_f32 v31, v31, v89
v_cvt_pk_bf16_f32 v31, v31, v31
v_lshlrev_b32 v31, 16, v31
v_mul_f32 v90, v31, v31
v_mov_b32 v91, 0x3d372713
v_fma_f32 v90, v90, v91, 1.0
v_mul_f32 v90, v90, v31
v_mul_f32 v90, 0x40135761, v90
v_exp_f32 v90, v90
s_nop 0
v_add_f32 v90, 1.0, v90
v_rcp_f32 v90, v90
s_nop 0
v_fma_f32 v90, v90, -2.0, 1.0
v_add_f32 v90, 1.0, v90
v_mul_f32 v90, 0.5, v90
v_mul_f32 v31, v31, v90
v_cvt_pk_bf16_f32 v28, v28, v29
v_cvt_pk_bf16_f32 v29, v30, v31
v_cvt_pk_bf16_f32 v44, v44, v44
v_lshlrev_b32 v44, 16, v44
v_add_f32 v44, v44, v86
v_cvt_pk_bf16_f32 v44, v44, v44
v_lshlrev_b32 v44, 16, v44
v_mul_f32 v90, v44, v44
v_mov_b32 v91, 0x3d372713
v_fma_f32 v90, v90, v91, 1.0
v_mul_f32 v90, v90, v44
v_mul_f32 v90, 0x40135761, v90
v_exp_f32 v90, v90
s_nop 0
v_add_f32 v90, 1.0, v90
v_rcp_f32 v90, v90
s_nop 0
v_fma_f32 v90, v90, -2.0, 1.0
v_add_f32 v90, 1.0, v90
v_mul_f32 v90, 0.5, v90
v_mul_f32 v44, v44, v90
v_cvt_pk_bf16_f32 v45, v45, v45
v_lshlrev_b32 v45, 16, v45
v_add_f32 v45, v45, v87
v_cvt_pk_bf16_f32 v45, v45, v45
v_lshlrev_b32 v45, 16, v45
v_mul_f32 v90, v45, v45
v_mov_b32 v91, 0x3d372713
v_fma_f32 v90, v90, v91, 1.0
v_mul_f32 v90, v90, v45
v_mul_f32 v90, 0x40135761, v90
v_exp_f32 v90, v90
s_nop 0
v_add_f32 v90, 1.0, v90
v_rcp_f32 v90, v90
s_nop 0
v_fma_f32 v90, v90, -2.0, 1.0
v_add_f32 v90, 1.0, v90
v_mul_f32 v90, 0.5, v90
v_mul_f32 v45, v45, v90
v_cvt_pk_bf16_f32 v46, v46, v46
v_lshlrev_b32 v46, 16, v46
v_add_f32 v46, v46, v88
v_cvt_pk_bf16_f32 v46, v46, v46
v_lshlrev_b32 v46, 16, v46
v_mul_f32 v90, v46, v46
v_mov_b32 v91, 0x3d372713
v_fma_f32 v90, v90, v91, 1.0
v_mul_f32 v90, v90, v46
v_mul_f32 v90, 0x40135761, v90
v_exp_f32 v90, v90
s_nop 0
v_add_f32 v90, 1.0, v90
v_rcp_f32 v90, v90
s_nop 0
v_fma_f32 v90, v90, -2.0, 1.0
v_add_f32 v90, 1.0, v90
v_mul_f32 v90, 0.5, v90
v_mul_f32 v46, v46, v90
v_cvt_pk_bf16_f32 v47, v47, v47
v_lshlrev_b32 v47, 16, v47
v_add_f32 v47, v47, v89
v_cvt_pk_bf16_f32 v47, v47, v47
v_lshlrev_b32 v47, 16, v47
v_mul_f32 v90, v47, v47
v_mov_b32 v91, 0x3d372713
v_fma_f32 v90, v90, v91, 1.0
v_mul_f32 v90, v90, v47
v_mul_f32 v90, 0x40135761, v90
v_exp_f32 v90, v90
s_nop 0
v_add_f32 v90, 1.0, v90
v_rcp_f32 v90, v90
s_nop 0
v_fma_f32 v90, v90, -2.0, 1.0
v_add_f32 v90, 1.0, v90
v_mul_f32 v90, 0.5, v90
v_mul_f32 v47, v47, v90
v_cvt_pk_bf16_f32 v44, v44, v45
v_cvt_pk_bf16_f32 v45, v46, v47
v_cvt_pk_bf16_f32 v60, v60, v60
v_lshlrev_b32 v60, 16, v60
v_add_f32 v60, v60, v86
v_cvt_pk_bf16_f32 v60, v60, v60
v_lshlrev_b32 v60, 16, v60
v_mul_f32 v90, v60, v60
v_mov_b32 v91, 0x3d372713
v_fma_f32 v90, v90, v91, 1.0
v_mul_f32 v90, v90, v60
v_mul_f32 v90, 0x40135761, v90
v_exp_f32 v90, v90
s_nop 0
v_add_f32 v90, 1.0, v90
v_rcp_f32 v90, v90
s_nop 0
v_fma_f32 v90, v90, -2.0, 1.0
v_add_f32 v90, 1.0, v90
v_mul_f32 v90, 0.5, v90
v_mul_f32 v60, v60, v90
v_cvt_pk_bf16_f32 v61, v61, v61
v_lshlrev_b32 v61, 16, v61
v_add_f32 v61, v61, v87
v_cvt_pk_bf16_f32 v61, v61, v61
v_lshlrev_b32 v61, 16, v61
v_mul_f32 v90, v61, v61
v_mov_b32 v91, 0x3d372713
v_fma_f32 v90, v90, v91, 1.0
v_mul_f32 v90, v90, v61
v_mul_f32 v90, 0x40135761, v90
v_exp_f32 v90, v90
s_nop 0
v_add_f32 v90, 1.0, v90
v_rcp_f32 v90, v90
s_nop 0
v_fma_f32 v90, v90, -2.0, 1.0
v_add_f32 v90, 1.0, v90
v_mul_f32 v90, 0.5, v90
v_mul_f32 v61, v61, v90
v_cvt_pk_bf16_f32 v62, v62, v62
v_lshlrev_b32 v62, 16, v62
v_add_f32 v62, v62, v88
v_cvt_pk_bf16_f32 v62, v62, v62
v_lshlrev_b32 v62, 16, v62
v_mul_f32 v90, v62, v62
v_mov_b32 v91, 0x3d372713
v_fma_f32 v90, v90, v91, 1.0
v_mul_f32 v90, v90, v62
v_mul_f32 v90, 0x40135761, v90
v_exp_f32 v90, v90
s_nop 0
v_add_f32 v90, 1.0, v90
v_rcp_f32 v90, v90
s_nop 0
v_fma_f32 v90, v90, -2.0, 1.0
v_add_f32 v90, 1.0, v90
v_mul_f32 v90, 0.5, v90
v_mul_f32 v62, v62, v90
v_cvt_pk_bf16_f32 v63, v63, v63
v_lshlrev_b32 v63, 16, v63
v_add_f32 v63, v63, v89
v_cvt_pk_bf16_f32 v63, v63, v63
v_lshlrev_b32 v63, 16, v63
v_mul_f32 v90, v63, v63
v_mov_b32 v91, 0x3d372713
v_fma_f32 v90, v90, v91, 1.0
v_mul_f32 v90, v90, v63
v_mul_f32 v90, 0x40135761, v90
v_exp_f32 v90, v90
s_nop 0
v_add_f32 v90, 1.0, v90
v_rcp_f32 v90, v90
s_nop 0
v_fma_f32 v90, v90, -2.0, 1.0
v_add_f32 v90, 1.0, v90
v_mul_f32 v90, 0.5, v90
v_mul_f32 v63, v63, v90
v_cvt_pk_bf16_f32 v60, v60, v61
v_cvt_pk_bf16_f32 v61, v62, v63
s_add_u32 s23, s22, s27
buffer_store_dwordx2 v[12:13], v94, s[8:11], s23 offen
s_add_u32 s23, s23, 44032
buffer_store_dwordx2 v[28:29], v94, s[8:11], s23 offen
s_add_u32 s23, s23, 44032
buffer_store_dwordx2 v[44:45], v94, s[8:11], s23 offen
s_add_u32 s23, s23, 44032
buffer_store_dwordx2 v[60:61], v94, s[8:11], s23 offen
s_add_u32 s23, s23, 44032
Lskip3_mlp1_kernel:
Lend_mlp1_kernel:
s_endpgm
.p2align 8
.globl mlp2_kernel
.type mlp2_kernel,@function
mlp2_kernel:
s_load_dwordx2 s[8:9], s[0:1], 112
s_waitcnt lgkmcnt(0)
s_mov_b32 s10, 268435456
s_mov_b32 s11, 0x00020000
s_mov_b32 s4, 64
s_cmp_ge_u32 s2, s4
s_cbranch_scc1 Lend_mlp2_kernel
s_and_b32 s5, s2, 15
s_lshr_b32 s6, s2, 4
v_lshrrev_b32 v2, 6, v0
s_nop 0
v_readfirstlane_b32 s3, v2
v_and_b32 v1, 63, v0
s_lshr_b32 s7, s3, 1
s_lshl_b32 s7, s7, 6
s_lshl_b32 s20, s5, 7
s_add_u32 s20, s20, s7
s_and_b32 s7, s3, 1
s_lshl_b32 s7, s7, 2
s_lshl_b32 s21, s6, 3
s_add_u32 s21, s21, s7
v_and_b32 v96, 15, v1
v_lshrrev_b32 v97, 4, v1
v_add_u32 v98, s20, v96
v_mul_u32_u24 v98, 2752, v98
v_lshl_add_u32 v98, v97, 4, v98
v_lshlrev_b32 v99, 4, v1
s_load_dwordx2 s[12:13], s[0:1], 88
s_waitcnt lgkmcnt(0)
s_mov_b32 s14, 1024
s_mov_b32 s15, 0x00020000
s_mov_b32 s27, 109051904
v_add_u32 v100, 100663296, v98
v_add_u32 v101, 100707328, v98
v_add_u32 v102, 100751360, v98
v_add_u32 v103, 100795392, v98
s_add_u32 s22, s21, 0
s_mul_i32 s22, s22, 44032
s_add_u32 s22, s22, 23068672
v_add_u32 v104, s22, v99
s_add_u32 s22, s21, 1
s_mul_i32 s22, s22, 44032
s_add_u32 s22, s22, 23068672
v_add_u32 v105, s22, v99
s_add_u32 s22, s21, 2
s_mul_i32 s22, s22, 44032
s_add_u32 s22, s22, 23068672
v_add_u32 v106, s22, v99
s_add_u32 s22, s21, 3
s_mul_i32 s22, s22, 44032
s_add_u32 s22, s22, 23068672
v_add_u32 v107, s22, v99
v_mov_b32 v0, 0
v_mov_b32 v1, 0
v_mov_b32 v2, 0
v_mov_b32 v3, 0
v_mov_b32 v4, 0
v_mov_b32 v5, 0
v_mov_b32 v6, 0
v_mov_b32 v7, 0
v_mov_b32 v8, 0
v_mov_b32 v9, 0
v_mov_b32 v10, 0
v_mov_b32 v11, 0
v_mov_b32 v12, 0
v_mov_b32 v13, 0
v_mov_b32 v14, 0
v_mov_b32 v15, 0
v_mov_b32 v16, 0
v_mov_b32 v17, 0
v_mov_b32 v18, 0
v_mov_b32 v19, 0
v_mov_b32 v20, 0
v_mov_b32 v21, 0
v_mov_b32 v22, 0
v_mov_b32 v23, 0
v_mov_b32 v24, 0
v_mov_b32 v25, 0
v_mov_b32 v26, 0
v_mov_b32 v27, 0
v_mov_b32 v28, 0
v_mov_b32 v29, 0
v_mov_b32 v30, 0
v_mov_b32 v31, 0
v_mov_b32 v32, 0
v_mov_b32 v33, 0
v_mov_b32 v34, 0
v_mov_b32 v35, 0
v_mov_b32 v36, 0
v_mov_b32 v37, 0
v_mov_b32 v38, 0
v_mov_b32 v39, 0
v_mov_b32 v40, 0
v_mov_b32 v41, 0
v_mov_b32 v42, 0
v_mov_b32 v43, 0
v_mov_b32 v44, 0
v_mov_b32 v45, 0
v_mov_b32 v46, 0
v_mov_b32 v47, 0
v_mov_b32 v48, 0
v_mov_b32 v49, 0
v_mov_b32 v50, 0
v_mov_b32 v51, 0
v_mov_b32 v52, 0
v_mov_b32 v53, 0
v_mov_b32 v54, 0
v_mov_b32 v55, 0
v_mov_b32 v56, 0
v_mov_b32 v57, 0
v_mov_b32 v58, 0
v_mov_b32 v59, 0
v_mov_b32 v60, 0
v_mov_b32 v61, 0
v_mov_b32 v62, 0
v_mov_b32 v63, 0
s_mov_b32 s24, 0
s_mov_b32 s25, 0
s_mov_b32 s26, 21
buffer_load_dwordx4 v[108:111], v100, s[8:11], s24 offen
buffer_load_dwordx4 v[112:115], v101, s[8:11], s24 offen
buffer_load_dwordx4 v[116:119], v102, s[8:11], s24 offen
buffer_load_dwordx4 v[120:123], v103, s[8:11], s24 offen
buffer_load_dwordx4 v[124:127], v104, s[8:11], s25 offen
buffer_load_dwordx4 v[128:131], v105, s[8:11], s25 offen
buffer_load_dwordx4 v[132:135], v106, s[8:11], s25 offen
buffer_load_dwordx4 v[136:139], v107, s[8:11], s25 offen
s_add_u32 s24, s24, 64
s_add_u32 s25, s25, 1024
Lmmlp2_kernel:
buffer_load_dwordx4 v[140:143], v100, s[8:11], s24 offen
buffer_load_dwordx4 v[144:147], v101, s[8:11], s24 offen
buffer_load_dwordx4 v[148:151], v102, s[8:11], s24 offen
buffer_load_dwordx4 v[152:155], v103, s[8:11], s24 offen
buffer_load_dwordx4 v[156:159], v104, s[8:11], s25 offen
buffer_load_dwordx4 v[160:163], v105, s[8:11], s25 offen
buffer_load_dwordx4 v[164:167], v106, s[8:11], s25 offen
buffer_load_dwordx4 v[168:171], v107, s[8:11], s25 offen
s_add_u32 s24, s24, 64
s_add_u32 s25, s25, 1024
s_waitcnt vmcnt(8)
v_mfma_f32_16x16x32_bf16 v[0:3], v[124:127], v[108:111], v[0:3]
v_mfma_f32_16x16x32_bf16 v[4:7], v[128:131], v[108:111], v[4:7]
v_mfma_f32_16x16x32_bf16 v[8:11], v[132:135], v[108:111], v[8:11]
v_mfma_f32_16x16x32_bf16 v[12:15], v[136:139], v[108:111], v[12:15]
v_mfma_f32_16x16x32_bf16 v[16:19], v[124:127], v[112:115], v[16:19]
v_mfma_f32_16x16x32_bf16 v[20:23], v[128:131], v[112:115], v[20:23]
v_mfma_f32_16x16x32_bf16 v[24:27], v[132:135], v[112:115], v[24:27]
v_mfma_f32_16x16x32_bf16 v[28:31], v[136:139], v[112:115], v[28:31]
v_mfma_f32_16x16x32_bf16 v[32:35], v[124:127], v[116:119], v[32:35]
v_mfma_f32_16x16x32_bf16 v[36:39], v[128:131], v[116:119], v[36:39]
v_mfma_f32_16x16x32_bf16 v[40:43], v[132:135], v[116:119], v[40:43]
v_mfma_f32_16x16x32_bf16 v[44:47], v[136:139], v[116:119], v[44:47]
v_mfma_f32_16x16x32_bf16 v[48:51], v[124:127], v[120:123], v[48:51]
v_mfma_f32_16x16x32_bf16 v[52:55], v[128:131], v[120:123], v[52:55]
v_mfma_f32_16x16x32_bf16 v[56:59], v[132:135], v[120:123], v[56:59]
v_mfma_f32_16x16x32_bf16 v[60:63], v[136:139], v[120:123], v[60:63]
buffer_load_dwordx4 v[108:111], v100, s[8:11], s24 offen
buffer_load_dwordx4 v[112:115], v101, s[8:11], s24 offen
buffer_load_dwordx4 v[116:119], v102, s[8:11], s24 offen
buffer_load_dwordx4 v[120:123], v103, s[8:11], s24 offen
buffer_load_dwordx4 v[124:127], v104, s[8:11], s25 offen
buffer_load_dwordx4 v[128:131], v105, s[8:11], s25 offen
buffer_load_dwordx4 v[132:135], v106, s[8:11], s25 offen
buffer_load_dwordx4 v[136:139], v107, s[8:11], s25 offen
s_add_u32 s24, s24, 64
s_add_u32 s25, s25, 1024
s_waitcnt vmcnt(8)
v_mfma_f32_16x16x32_bf16 v[0:3], v[156:159], v[140:143], v[0:3]
v_mfma_f32_16x16x32_bf16 v[4:7], v[160:163], v[140:143], v[4:7]
v_mfma_f32_16x16x32_bf16 v[8:11], v[164:167], v[140:143], v[8:11]
v_mfma_f32_16x16x32_bf16 v[12:15], v[168:171], v[140:143], v[12:15]
v_mfma_f32_16x16x32_bf16 v[16:19], v[156:159], v[144:147], v[16:19]
v_mfma_f32_16x16x32_bf16 v[20:23], v[160:163], v[144:147], v[20:23]
v_mfma_f32_16x16x32_bf16 v[24:27], v[164:167], v[144:147], v[24:27]
v_mfma_f32_16x16x32_bf16 v[28:31], v[168:171], v[144:147], v[28:31]
v_mfma_f32_16x16x32_bf16 v[32:35], v[156:159], v[148:151], v[32:35]
v_mfma_f32_16x16x32_bf16 v[36:39], v[160:163], v[148:151], v[36:39]
v_mfma_f32_16x16x32_bf16 v[40:43], v[164:167], v[148:151], v[40:43]
v_mfma_f32_16x16x32_bf16 v[44:47], v[168:171], v[148:151], v[44:47]
v_mfma_f32_16x16x32_bf16 v[48:51], v[156:159], v[152:155], v[48:51]
v_mfma_f32_16x16x32_bf16 v[52:55], v[160:163], v[152:155], v[52:55]
v_mfma_f32_16x16x32_bf16 v[56:59], v[164:167], v[152:155], v[56:59]
v_mfma_f32_16x16x32_bf16 v[60:63], v[168:171], v[152:155], v[60:63]
s_sub_u32 s26, s26, 1
s_cmp_lg_u32 s26, 0
s_cbranch_scc1 Lmmlp2_kernel
s_waitcnt vmcnt(0)
v_mfma_f32_16x16x32_bf16 v[0:3], v[124:127], v[108:111], v[0:3]
v_mfma_f32_16x16x32_bf16 v[4:7], v[128:131], v[108:111], v[4:7]
v_mfma_f32_16x16x32_bf16 v[8:11], v[132:135], v[108:111], v[8:11]
v_mfma_f32_16x16x32_bf16 v[12:15], v[136:139], v[108:111], v[12:15]
v_mfma_f32_16x16x32_bf16 v[16:19], v[124:127], v[112:115], v[16:19]
v_mfma_f32_16x16x32_bf16 v[20:23], v[128:131], v[112:115], v[20:23]
v_mfma_f32_16x16x32_bf16 v[24:27], v[132:135], v[112:115], v[24:27]
v_mfma_f32_16x16x32_bf16 v[28:31], v[136:139], v[112:115], v[28:31]
v_mfma_f32_16x16x32_bf16 v[32:35], v[124:127], v[116:119], v[32:35]
v_mfma_f32_16x16x32_bf16 v[36:39], v[128:131], v[116:119], v[36:39]
v_mfma_f32_16x16x32_bf16 v[40:43], v[132:135], v[116:119], v[40:43]
v_mfma_f32_16x16x32_bf16 v[44:47], v[136:139], v[116:119], v[44:47]
v_mfma_f32_16x16x32_bf16 v[48:51], v[124:127], v[120:123], v[48:51]
v_mfma_f32_16x16x32_bf16 v[52:55], v[128:131], v[120:123], v[52:55]
v_mfma_f32_16x16x32_bf16 v[56:59], v[132:135], v[120:123], v[56:59]
v_mfma_f32_16x16x32_bf16 v[60:63], v[136:139], v[120:123], v[60:63]
s_nop 15
v_add_u32 v94, s20, v96
v_mul_u32_u24 v94, 1024, v94
v_lshl_add_u32 v94, v97, 3, v94
s_add_u32 s22, s21, 0
s_lshl_b32 s22, s22, 5
v_lshlrev_b32 v95, 3, v97
buffer_load_dwordx2 v[84:85], v95, s[12:15], s22 offen
s_waitcnt vmcnt(0)
v_lshlrev_b32 v86, 16, v84
v_and_b32 v87, 0xffff0000, v84
v_lshlrev_b32 v88, 16, v85
v_and_b32 v89, 0xffff0000, v85
v_cvt_pk_bf16_f32 v0, v0, v0
v_lshlrev_b32 v0, 16, v0
v_add_f32 v0, v0, v86
v_cvt_pk_bf16_f32 v0, v0, v0
v_lshlrev_b32 v0, 16, v0
v_mul_f32 v90, 0xbfb8aa3b, v0
v_exp_f32 v90, v90
s_nop 0
v_add_f32 v90, 1.0, v90
v_rcp_f32 v90, v90
s_nop 0
v_mul_f32 v0, v0, v90
v_cvt_pk_bf16_f32 v1, v1, v1
v_lshlrev_b32 v1, 16, v1
v_add_f32 v1, v1, v87
v_cvt_pk_bf16_f32 v1, v1, v1
v_lshlrev_b32 v1, 16, v1
v_mul_f32 v90, 0xbfb8aa3b, v1
v_exp_f32 v90, v90
s_nop 0
v_add_f32 v90, 1.0, v90
v_rcp_f32 v90, v90
s_nop 0
v_mul_f32 v1, v1, v90
v_cvt_pk_bf16_f32 v2, v2, v2
v_lshlrev_b32 v2, 16, v2
v_add_f32 v2, v2, v88
v_cvt_pk_bf16_f32 v2, v2, v2
v_lshlrev_b32 v2, 16, v2
v_mul_f32 v90, 0xbfb8aa3b, v2
v_exp_f32 v90, v90
s_nop 0
v_add_f32 v90, 1.0, v90
v_rcp_f32 v90, v90
s_nop 0
v_mul_f32 v2, v2, v90
v_cvt_pk_bf16_f32 v3, v3, v3
v_lshlrev_b32 v3, 16, v3
v_add_f32 v3, v3, v89
v_cvt_pk_bf16_f32 v3, v3, v3
v_lshlrev_b32 v3, 16, v3
v_mul_f32 v90, 0xbfb8aa3b, v3
v_exp_f32 v90, v90
s_nop 0
v_add_f32 v90, 1.0, v90
v_rcp_f32 v90, v90
s_nop 0
v_mul_f32 v3, v3, v90
v_cvt_pk_bf16_f32 v0, v0, v1
v_cvt_pk_bf16_f32 v1, v2, v3
v_cvt_pk_bf16_f32 v16, v16, v16
v_lshlrev_b32 v16, 16, v16
v_add_f32 v16, v16, v86
v_cvt_pk_bf16_f32 v16, v16, v16
v_lshlrev_b32 v16, 16, v16
v_mul_f32 v90, 0xbfb8aa3b, v16
v_exp_f32 v90, v90
s_nop 0
v_add_f32 v90, 1.0, v90
v_rcp_f32 v90, v90
s_nop 0
v_mul_f32 v16, v16, v90
v_cvt_pk_bf16_f32 v17, v17, v17
v_lshlrev_b32 v17, 16, v17
v_add_f32 v17, v17, v87
v_cvt_pk_bf16_f32 v17, v17, v17
v_lshlrev_b32 v17, 16, v17
v_mul_f32 v90, 0xbfb8aa3b, v17
v_exp_f32 v90, v90
s_nop 0
v_add_f32 v90, 1.0, v90
v_rcp_f32 v90, v90
s_nop 0
v_mul_f32 v17, v17, v90
v_cvt_pk_bf16_f32 v18, v18, v18
v_lshlrev_b32 v18, 16, v18
v_add_f32 v18, v18, v88
v_cvt_pk_bf16_f32 v18, v18, v18
v_lshlrev_b32 v18, 16, v18
v_mul_f32 v90, 0xbfb8aa3b, v18
v_exp_f32 v90, v90
s_nop 0
v_add_f32 v90, 1.0, v90
v_rcp_f32 v90, v90
s_nop 0
v_mul_f32 v18, v18, v90
v_cvt_pk_bf16_f32 v19, v19, v19
v_lshlrev_b32 v19, 16, v19
v_add_f32 v19, v19, v89
v_cvt_pk_bf16_f32 v19, v19, v19
v_lshlrev_b32 v19, 16, v19
v_mul_f32 v90, 0xbfb8aa3b, v19
v_exp_f32 v90, v90
s_nop 0
v_add_f32 v90, 1.0, v90
v_rcp_f32 v90, v90
s_nop 0
v_mul_f32 v19, v19, v90
v_cvt_pk_bf16_f32 v16, v16, v17
v_cvt_pk_bf16_f32 v17, v18, v19
v_cvt_pk_bf16_f32 v32, v32, v32
v_lshlrev_b32 v32, 16, v32
v_add_f32 v32, v32, v86
v_cvt_pk_bf16_f32 v32, v32, v32
v_lshlrev_b32 v32, 16, v32
v_mul_f32 v90, 0xbfb8aa3b, v32
v_exp_f32 v90, v90
s_nop 0
v_add_f32 v90, 1.0, v90
v_rcp_f32 v90, v90
s_nop 0
v_mul_f32 v32, v32, v90
v_cvt_pk_bf16_f32 v33, v33, v33
v_lshlrev_b32 v33, 16, v33
v_add_f32 v33, v33, v87
v_cvt_pk_bf16_f32 v33, v33, v33
v_lshlrev_b32 v33, 16, v33
v_mul_f32 v90, 0xbfb8aa3b, v33
v_exp_f32 v90, v90
s_nop 0
v_add_f32 v90, 1.0, v90
v_rcp_f32 v90, v90
s_nop 0
v_mul_f32 v33, v33, v90
v_cvt_pk_bf16_f32 v34, v34, v34
v_lshlrev_b32 v34, 16, v34
v_add_f32 v34, v34, v88
v_cvt_pk_bf16_f32 v34, v34, v34
v_lshlrev_b32 v34, 16, v34
v_mul_f32 v90, 0xbfb8aa3b, v34
v_exp_f32 v90, v90
s_nop 0
v_add_f32 v90, 1.0, v90
v_rcp_f32 v90, v90
s_nop 0
v_mul_f32 v34, v34, v90
v_cvt_pk_bf16_f32 v35, v35, v35
v_lshlrev_b32 v35, 16, v35
v_add_f32 v35, v35, v89
v_cvt_pk_bf16_f32 v35, v35, v35
v_lshlrev_b32 v35, 16, v35
v_mul_f32 v90, 0xbfb8aa3b, v35
v_exp_f32 v90, v90
s_nop 0
v_add_f32 v90, 1.0, v90
v_rcp_f32 v90, v90
s_nop 0
v_mul_f32 v35, v35, v90
v_cvt_pk_bf16_f32 v32, v32, v33
v_cvt_pk_bf16_f32 v33, v34, v35
v_cvt_pk_bf16_f32 v48, v48, v48
v_lshlrev_b32 v48, 16, v48
v_add_f32 v48, v48, v86
v_cvt_pk_bf16_f32 v48, v48, v48
v_lshlrev_b32 v48, 16, v48
v_mul_f32 v90, 0xbfb8aa3b, v48
v_exp_f32 v90, v90
s_nop 0
v_add_f32 v90, 1.0, v90
v_rcp_f32 v90, v90
s_nop 0
v_mul_f32 v48, v48, v90
v_cvt_pk_bf16_f32 v49, v49, v49
v_lshlrev_b32 v49, 16, v49
v_add_f32 v49, v49, v87
v_cvt_pk_bf16_f32 v49, v49, v49
v_lshlrev_b32 v49, 16, v49
v_mul_f32 v90, 0xbfb8aa3b, v49
v_exp_f32 v90, v90
s_nop 0
v_add_f32 v90, 1.0, v90
v_rcp_f32 v90, v90
s_nop 0
v_mul_f32 v49, v49, v90
v_cvt_pk_bf16_f32 v50, v50, v50
v_lshlrev_b32 v50, 16, v50
v_add_f32 v50, v50, v88
v_cvt_pk_bf16_f32 v50, v50, v50
v_lshlrev_b32 v50, 16, v50
v_mul_f32 v90, 0xbfb8aa3b, v50
v_exp_f32 v90, v90
s_nop 0
v_add_f32 v90, 1.0, v90
v_rcp_f32 v90, v90
s_nop 0
v_mul_f32 v50, v50, v90
v_cvt_pk_bf16_f32 v51, v51, v51
v_lshlrev_b32 v51, 16, v51
v_add_f32 v51, v51, v89
v_cvt_pk_bf16_f32 v51, v51, v51
v_lshlrev_b32 v51, 16, v51
v_mul_f32 v90, 0xbfb8aa3b, v51
v_exp_f32 v90, v90
s_nop 0
v_add_f32 v90, 1.0, v90
v_rcp_f32 v90, v90
s_nop 0
v_mul_f32 v51, v51, v90
v_cvt_pk_bf16_f32 v48, v48, v49
v_cvt_pk_bf16_f32 v49, v50, v51
s_add_u32 s23, s22, s27
buffer_store_dwordx2 v[0:1], v94, s[8:11], s23 offen
s_add_u32 s23, s23, 16384
buffer_store_dwordx2 v[16:17], v94, s[8:11], s23 offen
s_add_u32 s23, s23, 16384
buffer_store_dwordx2 v[32:33], v94, s[8:11], s23 offen
s_add_u32 s23, s23, 16384
buffer_store_dwordx2 v[48:49], v94, s[8:11], s23 offen
s_add_u32 s23, s23, 16384
s_add_u32 s22, s21, 1
s_lshl_b32 s22, s22, 5
v_lshlrev_b32 v95, 3, v97
buffer_load_dwordx2 v[84:85], v95, s[12:15], s22 offen
s_waitcnt vmcnt(0)
v_lshlrev_b32 v86, 16, v84
v_and_b32 v87, 0xffff0000, v84
v_lshlrev_b32 v88, 16, v85
v_and_b32 v89, 0xffff0000, v85
v_cvt_pk_bf16_f32 v4, v4, v4
v_lshlrev_b32 v4, 16, v4
v_add_f32 v4, v4, v86
v_cvt_pk_bf16_f32 v4, v4, v4
v_lshlrev_b32 v4, 16, v4
v_mul_f32 v90, 0xbfb8aa3b, v4
v_exp_f32 v90, v90
s_nop 0
v_add_f32 v90, 1.0, v90
v_rcp_f32 v90, v90
s_nop 0
v_mul_f32 v4, v4, v90
v_cvt_pk_bf16_f32 v5, v5, v5
v_lshlrev_b32 v5, 16, v5
v_add_f32 v5, v5, v87
v_cvt_pk_bf16_f32 v5, v5, v5
v_lshlrev_b32 v5, 16, v5
v_mul_f32 v90, 0xbfb8aa3b, v5
v_exp_f32 v90, v90
s_nop 0
v_add_f32 v90, 1.0, v90
v_rcp_f32 v90, v90
s_nop 0
v_mul_f32 v5, v5, v90
v_cvt_pk_bf16_f32 v6, v6, v6
v_lshlrev_b32 v6, 16, v6
v_add_f32 v6, v6, v88
v_cvt_pk_bf16_f32 v6, v6, v6
v_lshlrev_b32 v6, 16, v6
v_mul_f32 v90, 0xbfb8aa3b, v6
v_exp_f32 v90, v90
s_nop 0
v_add_f32 v90, 1.0, v90
v_rcp_f32 v90, v90
s_nop 0
v_mul_f32 v6, v6, v90
v_cvt_pk_bf16_f32 v7, v7, v7
v_lshlrev_b32 v7, 16, v7
v_add_f32 v7, v7, v89
v_cvt_pk_bf16_f32 v7, v7, v7
v_lshlrev_b32 v7, 16, v7
v_mul_f32 v90, 0xbfb8aa3b, v7
v_exp_f32 v90, v90
s_nop 0
v_add_f32 v90, 1.0, v90
v_rcp_f32 v90, v90
s_nop 0
v_mul_f32 v7, v7, v90
v_cvt_pk_bf16_f32 v4, v4, v5
v_cvt_pk_bf16_f32 v5, v6, v7
v_cvt_pk_bf16_f32 v20, v20, v20
v_lshlrev_b32 v20, 16, v20
v_add_f32 v20, v20, v86
v_cvt_pk_bf16_f32 v20, v20, v20
v_lshlrev_b32 v20, 16, v20
v_mul_f32 v90, 0xbfb8aa3b, v20
v_exp_f32 v90, v90
s_nop 0
v_add_f32 v90, 1.0, v90
v_rcp_f32 v90, v90
s_nop 0
v_mul_f32 v20, v20, v90
v_cvt_pk_bf16_f32 v21, v21, v21
v_lshlrev_b32 v21, 16, v21
v_add_f32 v21, v21, v87
v_cvt_pk_bf16_f32 v21, v21, v21
v_lshlrev_b32 v21, 16, v21
v_mul_f32 v90, 0xbfb8aa3b, v21
v_exp_f32 v90, v90
s_nop 0
v_add_f32 v90, 1.0, v90
v_rcp_f32 v90, v90
s_nop 0
v_mul_f32 v21, v21, v90
v_cvt_pk_bf16_f32 v22, v22, v22
v_lshlrev_b32 v22, 16, v22
v_add_f32 v22, v22, v88
v_cvt_pk_bf16_f32 v22, v22, v22
v_lshlrev_b32 v22, 16, v22
v_mul_f32 v90, 0xbfb8aa3b, v22
v_exp_f32 v90, v90
s_nop 0
v_add_f32 v90, 1.0, v90
v_rcp_f32 v90, v90
s_nop 0
v_mul_f32 v22, v22, v90
v_cvt_pk_bf16_f32 v23, v23, v23
v_lshlrev_b32 v23, 16, v23
v_add_f32 v23, v23, v89
v_cvt_pk_bf16_f32 v23, v23, v23
v_lshlrev_b32 v23, 16, v23
v_mul_f32 v90, 0xbfb8aa3b, v23
v_exp_f32 v90, v90
s_nop 0
v_add_f32 v90, 1.0, v90
v_rcp_f32 v90, v90
s_nop 0
v_mul_f32 v23, v23, v90
v_cvt_pk_bf16_f32 v20, v20, v21
v_cvt_pk_bf16_f32 v21, v22, v23
v_cvt_pk_bf16_f32 v36, v36, v36
v_lshlrev_b32 v36, 16, v36
v_add_f32 v36, v36, v86
v_cvt_pk_bf16_f32 v36, v36, v36
v_lshlrev_b32 v36, 16, v36
v_mul_f32 v90, 0xbfb8aa3b, v36
v_exp_f32 v90, v90
s_nop 0
v_add_f32 v90, 1.0, v90
v_rcp_f32 v90, v90
s_nop 0
v_mul_f32 v36, v36, v90
v_cvt_pk_bf16_f32 v37, v37, v37
v_lshlrev_b32 v37, 16, v37
v_add_f32 v37, v37, v87
v_cvt_pk_bf16_f32 v37, v37, v37
v_lshlrev_b32 v37, 16, v37
v_mul_f32 v90, 0xbfb8aa3b, v37
v_exp_f32 v90, v90
s_nop 0
v_add_f32 v90, 1.0, v90
v_rcp_f32 v90, v90
s_nop 0
v_mul_f32 v37, v37, v90
v_cvt_pk_bf16_f32 v38, v38, v38
v_lshlrev_b32 v38, 16, v38
v_add_f32 v38, v38, v88
v_cvt_pk_bf16_f32 v38, v38, v38
v_lshlrev_b32 v38, 16, v38
v_mul_f32 v90, 0xbfb8aa3b, v38
v_exp_f32 v90, v90
s_nop 0
v_add_f32 v90, 1.0, v90
v_rcp_f32 v90, v90
s_nop 0
v_mul_f32 v38, v38, v90
v_cvt_pk_bf16_f32 v39, v39, v39
v_lshlrev_b32 v39, 16, v39
v_add_f32 v39, v39, v89
v_cvt_pk_bf16_f32 v39, v39, v39
v_lshlrev_b32 v39, 16, v39
v_mul_f32 v90, 0xbfb8aa3b, v39
v_exp_f32 v90, v90
s_nop 0
v_add_f32 v90, 1.0, v90
v_rcp_f32 v90, v90
s_nop 0
v_mul_f32 v39, v39, v90
v_cvt_pk_bf16_f32 v36, v36, v37
v_cvt_pk_bf16_f32 v37, v38, v39
v_cvt_pk_bf16_f32 v52, v52, v52
v_lshlrev_b32 v52, 16, v52
v_add_f32 v52, v52, v86
v_cvt_pk_bf16_f32 v52, v52, v52
v_lshlrev_b32 v52, 16, v52
v_mul_f32 v90, 0xbfb8aa3b, v52
v_exp_f32 v90, v90
s_nop 0
v_add_f32 v90, 1.0, v90
v_rcp_f32 v90, v90
s_nop 0
v_mul_f32 v52, v52, v90
v_cvt_pk_bf16_f32 v53, v53, v53
v_lshlrev_b32 v53, 16, v53
v_add_f32 v53, v53, v87
v_cvt_pk_bf16_f32 v53, v53, v53
v_lshlrev_b32 v53, 16, v53
v_mul_f32 v90, 0xbfb8aa3b, v53
v_exp_f32 v90, v90
s_nop 0
v_add_f32 v90, 1.0, v90
v_rcp_f32 v90, v90
s_nop 0
v_mul_f32 v53, v53, v90
v_cvt_pk_bf16_f32 v54, v54, v54
v_lshlrev_b32 v54, 16, v54
v_add_f32 v54, v54, v88
v_cvt_pk_bf16_f32 v54, v54, v54
v_lshlrev_b32 v54, 16, v54
v_mul_f32 v90, 0xbfb8aa3b, v54
v_exp_f32 v90, v90
s_nop 0
v_add_f32 v90, 1.0, v90
v_rcp_f32 v90, v90
s_nop 0
v_mul_f32 v54, v54, v90
v_cvt_pk_bf16_f32 v55, v55, v55
v_lshlrev_b32 v55, 16, v55
v_add_f32 v55, v55, v89
v_cvt_pk_bf16_f32 v55, v55, v55
v_lshlrev_b32 v55, 16, v55
v_mul_f32 v90, 0xbfb8aa3b, v55
v_exp_f32 v90, v90
s_nop 0
v_add_f32 v90, 1.0, v90
v_rcp_f32 v90, v90
s_nop 0
v_mul_f32 v55, v55, v90
v_cvt_pk_bf16_f32 v52, v52, v53
v_cvt_pk_bf16_f32 v53, v54, v55
s_add_u32 s23, s22, s27
buffer_store_dwordx2 v[4:5], v94, s[8:11], s23 offen
s_add_u32 s23, s23, 16384
buffer_store_dwordx2 v[20:21], v94, s[8:11], s23 offen
s_add_u32 s23, s23, 16384
buffer_store_dwordx2 v[36:37], v94, s[8:11], s23 offen
s_add_u32 s23, s23, 16384
buffer_store_dwordx2 v[52:53], v94, s[8:11], s23 offen
s_add_u32 s23, s23, 16384
s_add_u32 s22, s21, 2
s_lshl_b32 s22, s22, 5
v_lshlrev_b32 v95, 3, v97
buffer_load_dwordx2 v[84:85], v95, s[12:15], s22 offen
s_waitcnt vmcnt(0)
v_lshlrev_b32 v86, 16, v84
v_and_b32 v87, 0xffff0000, v84
v_lshlrev_b32 v88, 16, v85
v_and_b32 v89, 0xffff0000, v85
v_cvt_pk_bf16_f32 v8, v8, v8
v_lshlrev_b32 v8, 16, v8
v_add_f32 v8, v8, v86
v_cvt_pk_bf16_f32 v8, v8, v8
v_lshlrev_b32 v8, 16, v8
v_mul_f32 v90, 0xbfb8aa3b, v8
v_exp_f32 v90, v90
s_nop 0
v_add_f32 v90, 1.0, v90
v_rcp_f32 v90, v90
s_nop 0
v_mul_f32 v8, v8, v90
v_cvt_pk_bf16_f32 v9, v9, v9
v_lshlrev_b32 v9, 16, v9
v_add_f32 v9, v9, v87
v_cvt_pk_bf16_f32 v9, v9, v9
v_lshlrev_b32 v9, 16, v9
v_mul_f32 v90, 0xbfb8aa3b, v9
v_exp_f32 v90, v90
s_nop 0
v_add_f32 v90, 1.0, v90
v_rcp_f32 v90, v90
s_nop 0
v_mul_f32 v9, v9, v90
v_cvt_pk_bf16_f32 v10, v10, v10
v_lshlrev_b32 v10, 16, v10
v_add_f32 v10, v10, v88
v_cvt_pk_bf16_f32 v10, v10, v10
v_lshlrev_b32 v10, 16, v10
v_mul_f32 v90, 0xbfb8aa3b, v10
v_exp_f32 v90, v90
s_nop 0
v_add_f32 v90, 1.0, v90
v_rcp_f32 v90, v90
s_nop 0
v_mul_f32 v10, v10, v90
v_cvt_pk_bf16_f32 v11, v11, v11
v_lshlrev_b32 v11, 16, v11
v_add_f32 v11, v11, v89
v_cvt_pk_bf16_f32 v11, v11, v11
v_lshlrev_b32 v11, 16, v11
v_mul_f32 v90, 0xbfb8aa3b, v11
v_exp_f32 v90, v90
s_nop 0
v_add_f32 v90, 1.0, v90
v_rcp_f32 v90, v90
s_nop 0
v_mul_f32 v11, v11, v90
v_cvt_pk_bf16_f32 v8, v8, v9
v_cvt_pk_bf16_f32 v9, v10, v11
v_cvt_pk_bf16_f32 v24, v24, v24
v_lshlrev_b32 v24, 16, v24
v_add_f32 v24, v24, v86
v_cvt_pk_bf16_f32 v24, v24, v24
v_lshlrev_b32 v24, 16, v24
v_mul_f32 v90, 0xbfb8aa3b, v24
v_exp_f32 v90, v90
s_nop 0
v_add_f32 v90, 1.0, v90
v_rcp_f32 v90, v90
s_nop 0
v_mul_f32 v24, v24, v90
v_cvt_pk_bf16_f32 v25, v25, v25
v_lshlrev_b32 v25, 16, v25
v_add_f32 v25, v25, v87
v_cvt_pk_bf16_f32 v25, v25, v25
v_lshlrev_b32 v25, 16, v25
v_mul_f32 v90, 0xbfb8aa3b, v25
v_exp_f32 v90, v90
s_nop 0
v_add_f32 v90, 1.0, v90
v_rcp_f32 v90, v90
s_nop 0
v_mul_f32 v25, v25, v90
v_cvt_pk_bf16_f32 v26, v26, v26
v_lshlrev_b32 v26, 16, v26
v_add_f32 v26, v26, v88
v_cvt_pk_bf16_f32 v26, v26, v26
v_lshlrev_b32 v26, 16, v26
v_mul_f32 v90, 0xbfb8aa3b, v26
v_exp_f32 v90, v90
s_nop 0
v_add_f32 v90, 1.0, v90
v_rcp_f32 v90, v90
s_nop 0
v_mul_f32 v26, v26, v90
v_cvt_pk_bf16_f32 v27, v27, v27
v_lshlrev_b32 v27, 16, v27
v_add_f32 v27, v27, v89
v_cvt_pk_bf16_f32 v27, v27, v27
v_lshlrev_b32 v27, 16, v27
v_mul_f32 v90, 0xbfb8aa3b, v27
v_exp_f32 v90, v90
s_nop 0
v_add_f32 v90, 1.0, v90
v_rcp_f32 v90, v90
s_nop 0
v_mul_f32 v27, v27, v90
v_cvt_pk_bf16_f32 v24, v24, v25
v_cvt_pk_bf16_f32 v25, v26, v27
v_cvt_pk_bf16_f32 v40, v40, v40
v_lshlrev_b32 v40, 16, v40
v_add_f32 v40, v40, v86
v_cvt_pk_bf16_f32 v40, v40, v40
v_lshlrev_b32 v40, 16, v40
v_mul_f32 v90, 0xbfb8aa3b, v40
v_exp_f32 v90, v90
s_nop 0
v_add_f32 v90, 1.0, v90
v_rcp_f32 v90, v90
s_nop 0
v_mul_f32 v40, v40, v90
v_cvt_pk_bf16_f32 v41, v41, v41
v_lshlrev_b32 v41, 16, v41
v_add_f32 v41, v41, v87
v_cvt_pk_bf16_f32 v41, v41, v41
v_lshlrev_b32 v41, 16, v41
v_mul_f32 v90, 0xbfb8aa3b, v41
v_exp_f32 v90, v90
s_nop 0
v_add_f32 v90, 1.0, v90
v_rcp_f32 v90, v90
s_nop 0
v_mul_f32 v41, v41, v90
v_cvt_pk_bf16_f32 v42, v42, v42
v_lshlrev_b32 v42, 16, v42
v_add_f32 v42, v42, v88
v_cvt_pk_bf16_f32 v42, v42, v42
v_lshlrev_b32 v42, 16, v42
v_mul_f32 v90, 0xbfb8aa3b, v42
v_exp_f32 v90, v90
s_nop 0
v_add_f32 v90, 1.0, v90
v_rcp_f32 v90, v90
s_nop 0
v_mul_f32 v42, v42, v90
v_cvt_pk_bf16_f32 v43, v43, v43
v_lshlrev_b32 v43, 16, v43
v_add_f32 v43, v43, v89
v_cvt_pk_bf16_f32 v43, v43, v43
v_lshlrev_b32 v43, 16, v43
v_mul_f32 v90, 0xbfb8aa3b, v43
v_exp_f32 v90, v90
s_nop 0
v_add_f32 v90, 1.0, v90
v_rcp_f32 v90, v90
s_nop 0
v_mul_f32 v43, v43, v90
v_cvt_pk_bf16_f32 v40, v40, v41
v_cvt_pk_bf16_f32 v41, v42, v43
v_cvt_pk_bf16_f32 v56, v56, v56
v_lshlrev_b32 v56, 16, v56
v_add_f32 v56, v56, v86
v_cvt_pk_bf16_f32 v56, v56, v56
v_lshlrev_b32 v56, 16, v56
v_mul_f32 v90, 0xbfb8aa3b, v56
v_exp_f32 v90, v90
s_nop 0
v_add_f32 v90, 1.0, v90
v_rcp_f32 v90, v90
s_nop 0
v_mul_f32 v56, v56, v90
v_cvt_pk_bf16_f32 v57, v57, v57
v_lshlrev_b32 v57, 16, v57
v_add_f32 v57, v57, v87
v_cvt_pk_bf16_f32 v57, v57, v57
v_lshlrev_b32 v57, 16, v57
v_mul_f32 v90, 0xbfb8aa3b, v57
v_exp_f32 v90, v90
s_nop 0
v_add_f32 v90, 1.0, v90
v_rcp_f32 v90, v90
s_nop 0
v_mul_f32 v57, v57, v90
v_cvt_pk_bf16_f32 v58, v58, v58
v_lshlrev_b32 v58, 16, v58
v_add_f32 v58, v58, v88
v_cvt_pk_bf16_f32 v58, v58, v58
v_lshlrev_b32 v58, 16, v58
v_mul_f32 v90, 0xbfb8aa3b, v58
v_exp_f32 v90, v90
s_nop 0
v_add_f32 v90, 1.0, v90
v_rcp_f32 v90, v90
s_nop 0
v_mul_f32 v58, v58, v90
v_cvt_pk_bf16_f32 v59, v59, v59
v_lshlrev_b32 v59, 16, v59
v_add_f32 v59, v59, v89
v_cvt_pk_bf16_f32 v59, v59, v59
v_lshlrev_b32 v59, 16, v59
v_mul_f32 v90, 0xbfb8aa3b, v59
v_exp_f32 v90, v90
s_nop 0
v_add_f32 v90, 1.0, v90
v_rcp_f32 v90, v90
s_nop 0
v_mul_f32 v59, v59, v90
v_cvt_pk_bf16_f32 v56, v56, v57
v_cvt_pk_bf16_f32 v57, v58, v59
s_add_u32 s23, s22, s27
buffer_store_dwordx2 v[8:9], v94, s[8:11], s23 offen
s_add_u32 s23, s23, 16384
buffer_store_dwordx2 v[24:25], v94, s[8:11], s23 offen
s_add_u32 s23, s23, 16384
buffer_store_dwordx2 v[40:41], v94, s[8:11], s23 offen
s_add_u32 s23, s23, 16384
buffer_store_dwordx2 v[56:57], v94, s[8:11], s23 offen
s_add_u32 s23, s23, 16384
s_add_u32 s22, s21, 3
s_lshl_b32 s22, s22, 5
v_lshlrev_b32 v95, 3, v97
buffer_load_dwordx2 v[84:85], v95, s[12:15], s22 offen
s_waitcnt vmcnt(0)
v_lshlrev_b32 v86, 16, v84
v_and_b32 v87, 0xffff0000, v84
v_lshlrev_b32 v88, 16, v85
v_and_b32 v89, 0xffff0000, v85
v_cvt_pk_bf16_f32 v12, v12, v12
v_lshlrev_b32 v12, 16, v12
v_add_f32 v12, v12, v86
v_cvt_pk_bf16_f32 v12, v12, v12
v_lshlrev_b32 v12, 16, v12
v_mul_f32 v90, 0xbfb8aa3b, v12
v_exp_f32 v90, v90
s_nop 0
v_add_f32 v90, 1.0, v90
v_rcp_f32 v90, v90
s_nop 0
v_mul_f32 v12, v12, v90
v_cvt_pk_bf16_f32 v13, v13, v13
v_lshlrev_b32 v13, 16, v13
v_add_f32 v13, v13, v87
v_cvt_pk_bf16_f32 v13, v13, v13
v_lshlrev_b32 v13, 16, v13
v_mul_f32 v90, 0xbfb8aa3b, v13
v_exp_f32 v90, v90
s_nop 0
v_add_f32 v90, 1.0, v90
v_rcp_f32 v90, v90
s_nop 0
v_mul_f32 v13, v13, v90
v_cvt_pk_bf16_f32 v14, v14, v14
v_lshlrev_b32 v14, 16, v14
v_add_f32 v14, v14, v88
v_cvt_pk_bf16_f32 v14, v14, v14
v_lshlrev_b32 v14, 16, v14
v_mul_f32 v90, 0xbfb8aa3b, v14
v_exp_f32 v90, v90
s_nop 0
v_add_f32 v90, 1.0, v90
v_rcp_f32 v90, v90
s_nop 0
v_mul_f32 v14, v14, v90
v_cvt_pk_bf16_f32 v15, v15, v15
v_lshlrev_b32 v15, 16, v15
v_add_f32 v15, v15, v89
v_cvt_pk_bf16_f32 v15, v15, v15
v_lshlrev_b32 v15, 16, v15
v_mul_f32 v90, 0xbfb8aa3b, v15
v_exp_f32 v90, v90
s_nop 0
v_add_f32 v90, 1.0, v90
v_rcp_f32 v90, v90
s_nop 0
v_mul_f32 v15, v15, v90
v_cvt_pk_bf16_f32 v12, v12, v13
v_cvt_pk_bf16_f32 v13, v14, v15
v_cvt_pk_bf16_f32 v28, v28, v28
v_lshlrev_b32 v28, 16, v28
v_add_f32 v28, v28, v86
v_cvt_pk_bf16_f32 v28, v28, v28
v_lshlrev_b32 v28, 16, v28
v_mul_f32 v90, 0xbfb8aa3b, v28
v_exp_f32 v90, v90
s_nop 0
v_add_f32 v90, 1.0, v90
v_rcp_f32 v90, v90
s_nop 0
v_mul_f32 v28, v28, v90
v_cvt_pk_bf16_f32 v29, v29, v29
v_lshlrev_b32 v29, 16, v29
v_add_f32 v29, v29, v87
v_cvt_pk_bf16_f32 v29, v29, v29
v_lshlrev_b32 v29, 16, v29
v_mul_f32 v90, 0xbfb8aa3b, v29
v_exp_f32 v90, v90
s_nop 0
v_add_f32 v90, 1.0, v90
v_rcp_f32 v90, v90
s_nop 0
v_mul_f32 v29, v29, v90
v_cvt_pk_bf16_f32 v30, v30, v30
v_lshlrev_b32 v30, 16, v30
v_add_f32 v30, v30, v88
v_cvt_pk_bf16_f32 v30, v30, v30
v_lshlrev_b32 v30, 16, v30
v_mul_f32 v90, 0xbfb8aa3b, v30
v_exp_f32 v90, v90
s_nop 0
v_add_f32 v90, 1.0, v90
v_rcp_f32 v90, v90
s_nop 0
v_mul_f32 v30, v30, v90
v_cvt_pk_bf16_f32 v31, v31, v31
v_lshlrev_b32 v31, 16, v31
v_add_f32 v31, v31, v89
v_cvt_pk_bf16_f32 v31, v31, v31
v_lshlrev_b32 v31, 16, v31
v_mul_f32 v90, 0xbfb8aa3b, v31
v_exp_f32 v90, v90
s_nop 0
v_add_f32 v90, 1.0, v90
v_rcp_f32 v90, v90
s_nop 0
v_mul_f32 v31, v31, v90
v_cvt_pk_bf16_f32 v28, v28, v29
v_cvt_pk_bf16_f32 v29, v30, v31
v_cvt_pk_bf16_f32 v44, v44, v44
v_lshlrev_b32 v44, 16, v44
v_add_f32 v44, v44, v86
v_cvt_pk_bf16_f32 v44, v44, v44
v_lshlrev_b32 v44, 16, v44
v_mul_f32 v90, 0xbfb8aa3b, v44
v_exp_f32 v90, v90
s_nop 0
v_add_f32 v90, 1.0, v90
v_rcp_f32 v90, v90
s_nop 0
v_mul_f32 v44, v44, v90
v_cvt_pk_bf16_f32 v45, v45, v45
v_lshlrev_b32 v45, 16, v45
v_add_f32 v45, v45, v87
v_cvt_pk_bf16_f32 v45, v45, v45
v_lshlrev_b32 v45, 16, v45
v_mul_f32 v90, 0xbfb8aa3b, v45
v_exp_f32 v90, v90
s_nop 0
v_add_f32 v90, 1.0, v90
v_rcp_f32 v90, v90
s_nop 0
v_mul_f32 v45, v45, v90
v_cvt_pk_bf16_f32 v46, v46, v46
v_lshlrev_b32 v46, 16, v46
v_add_f32 v46, v46, v88
v_cvt_pk_bf16_f32 v46, v46, v46
v_lshlrev_b32 v46, 16, v46
v_mul_f32 v90, 0xbfb8aa3b, v46
v_exp_f32 v90, v90
s_nop 0
v_add_f32 v90, 1.0, v90
v_rcp_f32 v90, v90
s_nop 0
v_mul_f32 v46, v46, v90
v_cvt_pk_bf16_f32 v47, v47, v47
v_lshlrev_b32 v47, 16, v47
v_add_f32 v47, v47, v89
v_cvt_pk_bf16_f32 v47, v47, v47
v_lshlrev_b32 v47, 16, v47
v_mul_f32 v90, 0xbfb8aa3b, v47
v_exp_f32 v90, v90
s_nop 0
v_add_f32 v90, 1.0, v90
v_rcp_f32 v90, v90
s_nop 0
v_mul_f32 v47, v47, v90
v_cvt_pk_bf16_f32 v44, v44, v45
v_cvt_pk_bf16_f32 v45, v46, v47
v_cvt_pk_bf16_f32 v60, v60, v60
v_lshlrev_b32 v60, 16, v60
v_add_f32 v60, v60, v86
v_cvt_pk_bf16_f32 v60, v60, v60
v_lshlrev_b32 v60, 16, v60
v_mul_f32 v90, 0xbfb8aa3b, v60
v_exp_f32 v90, v90
s_nop 0
v_add_f32 v90, 1.0, v90
v_rcp_f32 v90, v90
s_nop 0
v_mul_f32 v60, v60, v90
v_cvt_pk_bf16_f32 v61, v61, v61
v_lshlrev_b32 v61, 16, v61
v_add_f32 v61, v61, v87
v_cvt_pk_bf16_f32 v61, v61, v61
v_lshlrev_b32 v61, 16, v61
v_mul_f32 v90, 0xbfb8aa3b, v61
v_exp_f32 v90, v90
s_nop 0
v_add_f32 v90, 1.0, v90
v_rcp_f32 v90, v90
s_nop 0
v_mul_f32 v61, v61, v90
v_cvt_pk_bf16_f32 v62, v62, v62
v_lshlrev_b32 v62, 16, v62
v_add_f32 v62, v62, v88
v_cvt_pk_bf16_f32 v62, v62, v62
v_lshlrev_b32 v62, 16, v62
v_mul_f32 v90, 0xbfb8aa3b, v62
v_exp_f32 v90, v90
s_nop 0
v_add_f32 v90, 1.0, v90
v_rcp_f32 v90, v90
s_nop 0
v_mul_f32 v62, v62, v90
v_cvt_pk_bf16_f32 v63, v63, v63
v_lshlrev_b32 v63, 16, v63
v_add_f32 v63, v63, v89
v_cvt_pk_bf16_f32 v63, v63, v63
v_lshlrev_b32 v63, 16, v63
v_mul_f32 v90, 0xbfb8aa3b, v63
v_exp_f32 v90, v90
s_nop 0
v_add_f32 v90, 1.0, v90
v_rcp_f32 v90, v90
s_nop 0
v_mul_f32 v63, v63, v90
v_cvt_pk_bf16_f32 v60, v60, v61
v_cvt_pk_bf16_f32 v61, v62, v63
s_add_u32 s23, s22, s27
buffer_store_dwordx2 v[12:13], v94, s[8:11], s23 offen
s_add_u32 s23, s23, 16384
buffer_store_dwordx2 v[28:29], v94, s[8:11], s23 offen
s_add_u32 s23, s23, 16384
buffer_store_dwordx2 v[44:45], v94, s[8:11], s23 offen
s_add_u32 s23, s23, 16384
buffer_store_dwordx2 v[60:61], v94, s[8:11], s23 offen
s_add_u32 s23, s23, 16384
Lend_mlp2_kernel:
s_endpgm
.p2align 8
.globl chain_kernel
.type chain_kernel,@function
chain_kernel:
s_load_dwordx2 s[8:9], s[0:1], 112
s_waitcnt lgkmcnt(0)
s_mov_b32 s10, 268435456
s_mov_b32 s11, 0x00020000
s_cmp_ge_u32 s2, 32
s_cbranch_scc1 Lend_chain
v_lshrrev_b32 v2, 6, v0
s_nop 0
v_readfirstlane_b32 s3, v2
v_and_b32 v1, 63, v0
v_lshlrev_b32 v63, 2, v1
v_and_b32 v62, 15, v1
v_lshrrev_b32 v58, 4, v1
v_lshlrev_b32 v61, 2, v58
v_mov_b32 v59, 0xce6e6b28
v_mov_b32 v57, 7
v_lshlrev_b32 v56, 4, v1
s_lshl_b32 s4, s2, 3
s_lshl_b32 s5, s3, 1
s_add_u32 s4, s4, s5
s_add_u32 s4, s4, 0
s_lshl_b32 s4, s4, 14
s_add_u32 s4, s4, 4194304
buffer_load_dwordx4 a[0:3], v56, s[8:11], s4 offen offset:0
buffer_load_dwordx4 a[4:7], v56, s[8:11], s4 offen offset:1024
buffer_load_dwordx4 a[8:11], v56, s[8:11], s4 offen offset:2048
buffer_load_dwordx4 a[12:15], v56, s[8:11], s4 offen offset:3072
s_add_u32 s6, s4, 4096
buffer_load_dwordx4 a[16:19], v56, s[8:11], s6 offen
s_add_u32 s6, s4, 5120
buffer_load_dwordx4 a[20:23], v56, s[8:11], s6 offen
s_add_u32 s6, s4, 6144
buffer_load_dwordx4 a[24:27], v56, s[8:11], s6 offen
s_add_u32 s6, s4, 7168
buffer_load_dwordx4 a[28:31], v56, s[8:11], s6 offen
s_add_u32 s6, s4, 8192
buffer_load_dwordx4 a[32:35], v56, s[8:11], s6 offen
s_add_u32 s6, s4, 9216
buffer_load_dwordx4 a[36:39], v56, s[8:11], s6 offen
s_add_u32 s6, s4, 10240
buffer_load_dwordx4 a[40:43], v56, s[8:11], s6 offen
s_add_u32 s6, s4, 11264
buffer_load_dwordx4 a[44:47], v56, s[8:11], s6 offen
s_add_u32 s6, s4, 12288
buffer_load_dwordx4 a[48:51], v56, s[8:11], s6 offen
s_add_u32 s6, s4, 13312
buffer_load_dwordx4 a[52:55], v56, s[8:11], s6 offen
s_add_u32 s6, s4, 14336
buffer_load_dwordx4 a[56:59], v56, s[8:11], s6 offen
s_add_u32 s6, s4, 15360
buffer_load_dwordx4 a[60:63], v56, s[8:11], s6 offen
s_waitcnt vmcnt(0)
s_lshl_b32 s4, s2, 3
s_lshl_b32 s5, s3, 1
s_add_u32 s4, s4, s5
s_add_u32 s4, s4, 1
s_lshl_b32 s4, s4, 14
s_add_u32 s4, s4, 4194304
buffer_load_dwordx4 a[64:67], v56, s[8:11], s4 offen offset:0
buffer_load_dwordx4 a[68:71], v56, s[8:11], s4 offen offset:1024
buffer_load_dwordx4 a[72:75], v56, s[8:11], s4 offen offset:2048
buffer_load_dwordx4 a[76:79], v56, s[8:11], s4 offen offset:3072
s_add_u32 s6, s4, 4096
buffer_load_dwordx4 a[80:83], v56, s[8:11], s6 offen
s_add_u32 s6, s4, 5120
buffer_load_dwordx4 a[84:87], v56, s[8:11], s6 offen
s_add_u32 s6, s4, 6144
buffer_load_dwordx4 a[88:91], v56, s[8:11], s6 offen
s_add_u32 s6, s4, 7168
buffer_load_dwordx4 a[92:95], v56, s[8:11], s6 offen
s_add_u32 s6, s4, 8192
buffer_load_dwordx4 a[96:99], v56, s[8:11], s6 offen
s_add_u32 s6, s4, 9216
buffer_load_dwordx4 a[100:103], v56, s[8:11], s6 offen
s_add_u32 s6, s4, 10240
buffer_load_dwordx4 a[104:107], v56, s[8:11], s6 offen
s_add_u32 s6, s4, 11264
buffer_load_dwordx4 a[108:111], v56, s[8:11], s6 offen
s_add_u32 s6, s4, 12288
buffer_load_dwordx4 a[112:115], v56, s[8:11], s6 offen
s_add_u32 s6, s4, 13312
buffer_load_dwordx4 a[116:119], v56, s[8:11], s6 offen
s_add_u32 s6, s4, 14336
buffer_load_dwordx4 a[120:123], v56, s[8:11], s6 offen
s_add_u32 s6, s4, 15360
buffer_load_dwordx4 a[124:127], v56, s[8:11], s6 offen
s_waitcnt vmcnt(0)
s_lshl_b32 s4, s2, 3
s_lshl_b32 s5, s3, 1
s_add_u32 s4, s4, s5
s_add_u32 s4, s4, 256
s_lshl_b32 s4, s4, 14
s_add_u32 s4, s4, 4194304
buffer_load_dwordx4 a[128:131], v56, s[8:11], s4 offen offset:0
buffer_load_dwordx4 a[132:135], v56, s[8:11], s4 offen offset:1024
buffer_load_dwordx4 a[136:139], v56, s[8:11], s4 offen offset:2048
buffer_load_dwordx4 a[140:143], v56, s[8:11], s4 offen offset:3072
s_add_u32 s6, s4, 4096
buffer_load_dwordx4 a[144:147], v56, s[8:11], s6 offen
s_add_u32 s6, s4, 5120
buffer_load_dwordx4 a[148:151], v56, s[8:11], s6 offen
s_add_u32 s6, s4, 6144
buffer_load_dwordx4 a[152:155], v56, s[8:11], s6 offen
s_add_u32 s6, s4, 7168
buffer_load_dwordx4 a[156:159], v56, s[8:11], s6 offen
s_add_u32 s6, s4, 8192
buffer_load_dwordx4 a[160:163], v56, s[8:11], s6 offen
s_add_u32 s6, s4, 9216
buffer_load_dwordx4 a[164:167], v56, s[8:11], s6 offen
s_add_u32 s6, s4, 10240
buffer_load_dwordx4 a[168:171], v56, s[8:11], s6 offen
s_add_u32 s6, s4, 11264
buffer_load_dwordx4 a[172:175], v56, s[8:11], s6 offen
s_add_u32 s6, s4, 12288
buffer_load_dwordx4 a[176:179], v56, s[8:11], s6 offen
s_add_u32 s6, s4, 13312
buffer_load_dwordx4 a[180:183], v56, s[8:11], s6 offen
s_add_u32 s6, s4, 14336
buffer_load_dwordx4 a[184:187], v56, s[8:11], s6 offen
s_add_u32 s6, s4, 15360
buffer_load_dwordx4 a[188:191], v56, s[8:11], s6 offen
s_waitcnt vmcnt(0)
s_lshl_b32 s4, s2, 3
s_lshl_b32 s5, s3, 1
s_add_u32 s4, s4, s5
s_add_u32 s4, s4, 257
s_lshl_b32 s4, s4, 14
s_add_u32 s4, s4, 4194304
buffer_load_dwordx4 a[192:195], v56, s[8:11], s4 offen offset:0
buffer_load_dwordx4 a[196:199], v56, s[8:11], s4 offen offset:1024
buffer_load_dwordx4 a[200:203], v56, s[8:11], s4 offen offset:2048
buffer_load_dwordx4 a[204:207], v56, s[8:11], s4 offen offset:3072
s_add_u32 s6, s4, 4096
buffer_load_dwordx4 a[208:211], v56, s[8:11], s6 offen
s_add_u32 s6, s4, 5120
buffer_load_dwordx4 a[212:215], v56, s[8:11], s6 offen
s_add_u32 s6, s4, 6144
buffer_load_dwordx4 a[216:219], v56, s[8:11], s6 offen
s_add_u32 s6, s4, 7168
buffer_load_dwordx4 a[220:223], v56, s[8:11], s6 offen
s_add_u32 s6, s4, 8192
buffer_load_dwordx4 a[224:227], v56, s[8:11], s6 offen
s_add_u32 s6, s4, 9216
buffer_load_dwordx4 a[228:231], v56, s[8:11], s6 offen
s_add_u32 s6, s4, 10240
buffer_load_dwordx4 a[232:235], v56, s[8:11], s6 offen
s_add_u32 s6, s4, 11264
buffer_load_dwordx4 a[236:239], v56, s[8:11], s6 offen
s_add_u32 s6, s4, 12288
buffer_load_dwordx4 a[240:243], v56, s[8:11], s6 offen
s_add_u32 s6, s4, 13312
buffer_load_dwordx4 a[244:247], v56, s[8:11], s6 offen
s_add_u32 s6, s4, 14336
buffer_load_dwordx4 a[248:251], v56, s[8:11], s6 offen
s_add_u32 s6, s4, 15360
buffer_load_dwordx4 a[252:255], v56, s[8:11], s6 offen
s_waitcnt vmcnt(0)
s_lshl_b32 s4, s2, 3
s_lshl_b32 s5, s3, 1
s_add_u32 s4, s4, s5
s_add_u32 s4, s4, 512
s_lshl_b32 s4, s4, 14
s_add_u32 s4, s4, 4194304
buffer_load_dwordx4 v[128:131], v56, s[8:11], s4 offen offset:0
buffer_load_dwordx4 v[132:135], v56, s[8:11], s4 offen offset:1024
buffer_load_dwordx4 v[136:139], v56, s[8:11], s4 offen offset:2048
buffer_load_dwordx4 v[140:143], v56, s[8:11], s4 offen offset:3072
s_add_u32 s6, s4, 4096
buffer_load_dwordx4 v[144:147], v56, s[8:11], s6 offen
s_add_u32 s6, s4, 5120
buffer_load_dwordx4 v[148:151], v56, s[8:11], s6 offen
s_add_u32 s6, s4, 6144
buffer_load_dwordx4 v[152:155], v56, s[8:11], s6 offen
s_add_u32 s6, s4, 7168
buffer_load_dwordx4 v[156:159], v56, s[8:11], s6 offen
s_add_u32 s6, s4, 8192
buffer_load_dwordx4 v[160:163], v56, s[8:11], s6 offen
s_add_u32 s6, s4, 9216
buffer_load_dwordx4 v[164:167], v56, s[8:11], s6 offen
s_add_u32 s6, s4, 10240
buffer_load_dwordx4 v[168:171], v56, s[8:11], s6 offen
s_add_u32 s6, s4, 11264
buffer_load_dwordx4 v[172:175], v56, s[8:11], s6 offen
s_add_u32 s6, s4, 12288
buffer_load_dwordx4 v[176:179], v56, s[8:11], s6 offen
s_add_u32 s6, s4, 13312
buffer_load_dwordx4 v[180:183], v56, s[8:11], s6 offen
s_add_u32 s6, s4, 14336
buffer_load_dwordx4 v[184:187], v56, s[8:11], s6 offen
s_add_u32 s6, s4, 15360
buffer_load_dwordx4 v[188:191], v56, s[8:11], s6 offen
s_waitcnt vmcnt(0)
s_lshl_b32 s4, s2, 3
s_lshl_b32 s5, s3, 1
s_add_u32 s4, s4, s5
s_add_u32 s4, s4, 513
s_lshl_b32 s4, s4, 14
s_add_u32 s4, s4, 4194304
buffer_load_dwordx4 v[192:195], v56, s[8:11], s4 offen offset:0
buffer_load_dwordx4 v[196:199], v56, s[8:11], s4 offen offset:1024
buffer_load_dwordx4 v[200:203], v56, s[8:11], s4 offen offset:2048
buffer_load_dwordx4 v[204:207], v56, s[8:11], s4 offen offset:3072
s_add_u32 s6, s4, 4096
buffer_load_dwordx4 v[208:211], v56, s[8:11], s6 offen
s_add_u32 s6, s4, 5120
buffer_load_dwordx4 v[212:215], v56, s[8:11], s6 offen
s_add_u32 s6, s4, 6144
buffer_load_dwordx4 v[216:219], v56, s[8:11], s6 offen
s_add_u32 s6, s4, 7168
buffer_load_dwordx4 v[220:223], v56, s[8:11], s6 offen
s_add_u32 s6, s4, 8192
buffer_load_dwordx4 v[224:227], v56, s[8:11], s6 offen
s_add_u32 s6, s4, 9216
buffer_load_dwordx4 v[228:231], v56, s[8:11], s6 offen
s_add_u32 s6, s4, 10240
buffer_load_dwordx4 v[232:235], v56, s[8:11], s6 offen
s_add_u32 s6, s4, 11264
buffer_load_dwordx4 v[236:239], v56, s[8:11], s6 offen
s_add_u32 s6, s4, 12288
buffer_load_dwordx4 v[240:243], v56, s[8:11], s6 offen
s_add_u32 s6, s4, 13312
buffer_load_dwordx4 v[244:247], v56, s[8:11], s6 offen
s_add_u32 s6, s4, 14336
buffer_load_dwordx4 v[248:251], v56, s[8:11], s6 offen
s_add_u32 s6, s4, 15360
buffer_load_dwordx4 v[252:255], v56, s[8:11], s6 offen
s_waitcnt vmcnt(0)
s_lshl_b32 s4, s3, 3
s_add_u32 s4, s4, 0
s_lshl_b32 s5, s4, 17
s_lshl_b32 s6, s2, 12
s_add_u32 s5, s5, s6
s_add_u32 s5, s5, 16777216
s_lshl_b32 s4, s4, 12
s_add_u32 s4, s4, 32768
v_add_u32 v2, s4, v56
buffer_load_dwordx4 v[4:7], v56, s[8:11], s5 offen offset:0
buffer_load_dwordx4 v[8:11], v56, s[8:11], s5 offen offset:1024
buffer_load_dwordx4 v[12:15], v56, s[8:11], s5 offen offset:2048
buffer_load_dwordx4 v[16:19], v56, s[8:11], s5 offen offset:3072
s_waitcnt vmcnt(0)
ds_write_b128 v2, v[4:7] offset:0
ds_write_b128 v2, v[8:11] offset:1024
ds_write_b128 v2, v[12:15] offset:2048
ds_write_b128 v2, v[16:19] offset:3072
s_lshl_b32 s4, s3, 3
s_add_u32 s4, s4, 1
s_lshl_b32 s5, s4, 17
s_lshl_b32 s6, s2, 12
s_add_u32 s5, s5, s6
s_add_u32 s5, s5, 16777216
s_lshl_b32 s4, s4, 12
s_add_u32 s4, s4, 32768
v_add_u32 v2, s4, v56
buffer_load_dwordx4 v[4:7], v56, s[8:11], s5 offen offset:0
buffer_load_dwordx4 v[8:11], v56, s[8:11], s5 offen offset:1024
buffer_load_dwordx4 v[12:15], v56, s[8:11], s5 offen offset:2048
buffer_load_dwordx4 v[16:19], v56, s[8:11], s5 offen offset:3072
s_waitcnt vmcnt(0)
ds_write_b128 v2, v[4:7] offset:0
ds_write_b128 v2, v[8:11] offset:1024
ds_write_b128 v2, v[12:15] offset:2048
ds_write_b128 v2, v[16:19] offset:3072
s_lshl_b32 s4, s3, 3
s_add_u32 s4, s4, 2
s_lshl_b32 s5, s4, 17
s_lshl_b32 s6, s2, 12
s_add_u32 s5, s5, s6
s_add_u32 s5, s5, 16777216
s_lshl_b32 s4, s4, 12
s_add_u32 s4, s4, 32768
v_add_u32 v2, s4, v56
buffer_load_dwordx4 v[4:7], v56, s[8:11], s5 offen offset:0
buffer_load_dwordx4 v[8:11], v56, s[8:11], s5 offen offset:1024
buffer_load_dwordx4 v[12:15], v56, s[8:11], s5 offen offset:2048
buffer_load_dwordx4 v[16:19], v56, s[8:11], s5 offen offset:3072
s_waitcnt vmcnt(0)
ds_write_b128 v2, v[4:7] offset:0
ds_write_b128 v2, v[8:11] offset:1024
ds_write_b128 v2, v[12:15] offset:2048
ds_write_b128 v2, v[16:19] offset:3072
s_lshl_b32 s4, s3, 3
s_add_u32 s4, s4, 3
s_lshl_b32 s5, s4, 17
s_lshl_b32 s6, s2, 12
s_add_u32 s5, s5, s6
s_add_u32 s5, s5, 16777216
s_lshl_b32 s4, s4, 12
s_add_u32 s4, s4, 32768
v_add_u32 v2, s4, v56
buffer_load_dwordx4 v[4:7], v56, s[8:11], s5 offen offset:0
buffer_load_dwordx4 v[8:11], v56, s[8:11], s5 offen offset:1024
buffer_load_dwordx4 v[12:15], v56, s[8:11], s5 offen offset:2048
buffer_load_dwordx4 v[16:19], v56, s[8:11], s5 offen offset:3072
s_waitcnt vmcnt(0)
ds_write_b128 v2, v[4:7] offset:0
ds_write_b128 v2, v[8:11] offset:1024
ds_write_b128 v2, v[12:15] offset:2048
ds_write_b128 v2, v[16:19] offset:3072
s_lshl_b32 s4, s3, 3
s_add_u32 s4, s4, 4
s_lshl_b32 s5, s4, 17
s_lshl_b32 s6, s2, 12
s_add_u32 s5, s5, s6
s_add_u32 s5, s5, 16777216
s_lshl_b32 s4, s4, 12
s_add_u32 s4, s4, 32768
v_add_u32 v2, s4, v56
buffer_load_dwordx4 v[4:7], v56, s[8:11], s5 offen offset:0
buffer_load_dwordx4 v[8:11], v56, s[8:11], s5 offen offset:1024
buffer_load_dwordx4 v[12:15], v56, s[8:11], s5 offen offset:2048
buffer_load_dwordx4 v[16:19], v56, s[8:11], s5 offen offset:3072
s_waitcnt vmcnt(0)
ds_write_b128 v2, v[4:7] offset:0
ds_write_b128 v2, v[8:11] offset:1024
ds_write_b128 v2, v[12:15] offset:2048
ds_write_b128 v2, v[16:19] offset:3072
s_lshl_b32 s4, s3, 3
s_add_u32 s4, s4, 5
s_lshl_b32 s5, s4, 17
s_lshl_b32 s6, s2, 12
s_add_u32 s5, s5, s6
s_add_u32 s5, s5, 16777216
s_lshl_b32 s4, s4, 12
s_add_u32 s4, s4, 32768
v_add_u32 v2, s4, v56
buffer_load_dwordx4 v[4:7], v56, s[8:11], s5 offen offset:0
buffer_load_dwordx4 v[8:11], v56, s[8:11], s5 offen offset:1024
buffer_load_dwordx4 v[12:15], v56, s[8:11], s5 offen offset:2048
buffer_load_dwordx4 v[16:19], v56, s[8:11], s5 offen offset:3072
s_waitcnt vmcnt(0)
ds_write_b128 v2, v[4:7] offset:0
ds_write_b128 v2, v[8:11] offset:1024
ds_write_b128 v2, v[12:15] offset:2048
ds_write_b128 v2, v[16:19] offset:3072
s_lshl_b32 s4, s3, 3
s_add_u32 s4, s4, 6
s_lshl_b32 s5, s4, 17
s_lshl_b32 s6, s2, 12
s_add_u32 s5, s5, s6
s_add_u32 s5, s5, 16777216
s_lshl_b32 s4, s4, 12
s_add_u32 s4, s4, 32768
v_add_u32 v2, s4, v56
buffer_load_dwordx4 v[4:7], v56, s[8:11], s5 offen offset:0
buffer_load_dwordx4 v[8:11], v56, s[8:11], s5 offen offset:1024
buffer_load_dwordx4 v[12:15], v56, s[8:11], s5 offen offset:2048
buffer_load_dwordx4 v[16:19], v56, s[8:11], s5 offen offset:3072
s_waitcnt vmcnt(0)
ds_write_b128 v2, v[4:7] offset:0
ds_write_b128 v2, v[8:11] offset:1024
ds_write_b128 v2, v[12:15] offset:2048
ds_write_b128 v2, v[16:19] offset:3072
s_lshl_b32 s4, s3, 3
s_add_u32 s4, s4, 7
s_lshl_b32 s5, s4, 17
s_lshl_b32 s6, s2, 12
s_add_u32 s5, s5, s6
s_add_u32 s5, s5, 16777216
s_lshl_b32 s4, s4, 12
s_add_u32 s4, s4, 32768
v_add_u32 v2, s4, v56
buffer_load_dwordx4 v[4:7], v56, s[8:11], s5 offen offset:0
buffer_load_dwordx4 v[8:11], v56, s[8:11], s5 offen offset:1024
buffer_load_dwordx4 v[12:15], v56, s[8:11], s5 offen offset:2048
buffer_load_dwordx4 v[16:19], v56, s[8:11], s5 offen offset:3072
s_waitcnt vmcnt(0)
ds_write_b128 v2, v[4:7] offset:0
ds_write_b128 v2, v[8:11] offset:1024
ds_write_b128 v2, v[12:15] offset:2048
ds_write_b128 v2, v[16:19] offset:3072
s_load_dwordx2 s[12:13], s[0:1], 8
s_waitcnt lgkmcnt(0)
s_mov_b32 s14, 8192
s_mov_b32 s15, 0x00020000
v_lshlrev_b32 v2, 5, v0
buffer_load_dwordx4 v[4:7], v2, s[12:15], 0 offen
buffer_load_dwordx4 v[8:11], v2, s[12:15], 0 offen offset:16
v_lshrrev_b32 v3, 5, v0
v_mul_u32_u24 v3, 1040, v3
v_and_b32 v2, 31, v0
v_lshl_add_u32 v3, v2, 5, v3
s_waitcnt vmcnt(0)
ds_write_b128 v3, v[4:7] offset:0
ds_write_b128 v3, v[8:11] offset:16
s_mov_b32 s30, 0
Lstep:
v_lshrrev_b32 v2, 3, v0
v_and_b32 v3, 7, v0
v_lshlrev_b32 v4, 13, v2
v_lshl_add_u32 v4, v3, 5, v4
s_lshl_b32 s4, s30, 18
s_lshl_b32 s5, s2, 8
s_add_u32 s4, s4, s5
s_add_u32 s4, s4, 50331648
s_lshl_b32 s5, s30, 5
s_add_u32 s5, s5, s2
s_lshl_b32 s5, s5, 13
s_add_u32 s5, s5, 67108864
v_lshlrev_b32 v5, 5, v0
buffer_load_dwordx4 v[8:11], v4, s[8:11], s4 offen
buffer_load_dwordx4 v[12:15], v4, s[8:11], s4 offen offset:16
buffer_load_dwordx4 v[16:19], v5, s[8:11], s5 offen
buffer_load_dwordx4 v[20:23], v5, s[8:11], s5 offen offset:16
v_mul_u32_u24 v6, 272, v2
v_lshl_add_u32 v6, v3, 5, v6
v_lshrrev_b32 v2, 1, v0
v_mul_u32_u24 v7, 72, v2
v_and_b32 v3, 1, v0
v_lshl_add_u32 v7, v3, 5, v7
s_waitcnt vmcnt(0)
ds_write_b128 v6, v[8:11] offset:14848
ds_write_b128 v6, v[12:15] offset:14864
ds_write_b64 v7, v[16:17] offset:23552
ds_write_b64 v7, v[18:19] offset:23560
ds_write_b64 v7, v[20:21] offset:23568
ds_write_b64 v7, v[22:23] offset:23576
s_cmp_eq_u32 s30, 0
s_cbranch_scc1 Lnopoll
v_lshlrev_b32 v2, 4, v0
Lpoll2:
s_mov_b32 s4, 120586240
buffer_load_dwordx4 v[4:7], v2, s[8:11], s4 offen sc1
s_mov_b32 s4, 120590336
buffer_load_dwordx4 v[8:11], v2, s[8:11], s4 offen sc1
s_mov_b32 s4, 120594432
buffer_load_dwordx4 v[12:15], v2, s[8:11], s4 offen sc1
s_mov_b32 s4, 120598528
buffer_load_dwordx4 v[16:19], v2, s[8:11], s4 offen sc1
s_waitcnt vmcnt(0)
v_xor_b32 v3, s30, v5
v_xor_b32 v24, s30, v7
v_or_b32 v3, v3, v24
v_xor_b32 v24, s30, v9
v_or_b32 v3, v3, v24
v_xor_b32 v24, s30, v11
v_or_b32 v3, v3, v24
v_xor_b32 v24, s30, v13
v_or_b32 v3, v3, v24
v_xor_b32 v24, s30, v15
v_or_b32 v3, v3, v24
v_xor_b32 v24, s30, v17
v_or_b32 v3, v3, v24
v_xor_b32 v24, s30, v19
v_or_b32 v3, v3, v24
v_cmp_ne_u32 vcc, 0, v3
s_cbranch_vccnz Lpoll2
v_bfe_u32 v3, v0, 2, 3
v_mul_u32_u24 v3, 1040, v3
v_lshrrev_b32 v24, 5, v0
v_lshl_add_u32 v3, v24, 5, v3
v_and_b32 v24, 3, v0
v_lshl_add_u32 v3, v24, 3, v3
v_mov_b32 v5, v6
ds_write_b64 v3, v[4:5] offset:0
v_mov_b32 v9, v10
ds_write_b64 v3, v[8:9] offset:256
v_mov_b32 v13, v14
ds_write_b64 v3, v[12:13] offset:512
v_mov_b32 v17, v18
ds_write_b64 v3, v[16:17] offset:768
Lnopoll:
s_waitcnt lgkmcnt(0)
s_barrier
v_and_b32 v2, 7, v1
v_mul_u32_u24 v2, 1040, v2
v_lshl_add_u32 v2, v58, 4, v2
ds_read_b128 v[64:67], v2 offset:0
ds_read_b128 v[68:71], v2 offset:64
ds_read_b128 v[72:75], v2 offset:128
ds_read_b128 v[76:79], v2 offset:192
ds_read_b128 v[80:83], v2 offset:256
ds_read_b128 v[84:87], v2 offset:320
ds_read_b128 v[88:91], v2 offset:384
ds_read_b128 v[92:95], v2 offset:448
ds_read_b128 v[96:99], v2 offset:512
ds_read_b128 v[100:103], v2 offset:576
ds_read_b128 v[104:107], v2 offset:640
ds_read_b128 v[108:111], v2 offset:704
ds_read_b128 v[112:115], v2 offset:768
ds_read_b128 v[116:119], v2 offset:832
ds_read_b128 v[120:123], v2 offset:896
ds_read_b128 v[124:127], v2 offset:960
v_mov_b32 v8, 0
v_mov_b32 v9, 0
v_mov_b32 v10, 0
v_mov_b32 v11, 0
v_mov_b32 v12, 0
v_mov_b32 v13, 0
v_mov_b32 v14, 0
v_mov_b32 v15, 0
v_mov_b32 v16, 0
v_mov_b32 v17, 0
v_mov_b32 v18, 0
v_mov_b32 v19, 0
v_mov_b32 v20, 0
v_mov_b32 v21, 0
v_mov_b32 v22, 0
v_mov_b32 v23, 0
v_mov_b32 v24, 0
v_mov_b32 v25, 0
v_mov_b32 v26, 0
v_mov_b32 v27, 0
v_mov_b32 v28, 0
v_mov_b32 v29, 0
v_mov_b32 v30, 0
v_mov_b32 v31, 0
s_waitcnt lgkmcnt(0)
v_mfma_f32_16x16x32_bf16 v[8:11], a[0:3], v[64:67], v[8:11]
v_mfma_f32_16x16x32_bf16 v[12:15], a[64:67], v[64:67], v[12:15]
v_mfma_f32_16x16x32_bf16 v[16:19], a[128:131], v[64:67], v[16:19]
v_mfma_f32_16x16x32_bf16 v[20:23], a[192:195], v[64:67], v[20:23]
v_mfma_f32_16x16x32_bf16 v[24:27], v[64:67], v[128:131], v[24:27]
v_mfma_f32_16x16x32_bf16 v[28:31], v[64:67], v[192:195], v[28:31]
v_mfma_f32_16x16x32_bf16 v[8:11], a[4:7], v[68:71], v[8:11]
v_mfma_f32_16x16x32_bf16 v[12:15], a[68:71], v[68:71], v[12:15]
v_mfma_f32_16x16x32_bf16 v[16:19], a[132:135], v[68:71], v[16:19]
v_mfma_f32_16x16x32_bf16 v[20:23], a[196:199], v[68:71], v[20:23]
v_mfma_f32_16x16x32_bf16 v[24:27], v[68:71], v[132:135], v[24:27]
v_mfma_f32_16x16x32_bf16 v[28:31], v[68:71], v[196:199], v[28:31]
v_mfma_f32_16x16x32_bf16 v[8:11], a[8:11], v[72:75], v[8:11]
v_mfma_f32_16x16x32_bf16 v[12:15], a[72:75], v[72:75], v[12:15]
v_mfma_f32_16x16x32_bf16 v[16:19], a[136:139], v[72:75], v[16:19]
v_mfma_f32_16x16x32_bf16 v[20:23], a[200:203], v[72:75], v[20:23]
v_mfma_f32_16x16x32_bf16 v[24:27], v[72:75], v[136:139], v[24:27]
v_mfma_f32_16x16x32_bf16 v[28:31], v[72:75], v[200:203], v[28:31]
v_mfma_f32_16x16x32_bf16 v[8:11], a[12:15], v[76:79], v[8:11]
v_mfma_f32_16x16x32_bf16 v[12:15], a[76:79], v[76:79], v[12:15]
v_mfma_f32_16x16x32_bf16 v[16:19], a[140:143], v[76:79], v[16:19]
v_mfma_f32_16x16x32_bf16 v[20:23], a[204:207], v[76:79], v[20:23]
v_mfma_f32_16x16x32_bf16 v[24:27], v[76:79], v[140:143], v[24:27]
v_mfma_f32_16x16x32_bf16 v[28:31], v[76:79], v[204:207], v[28:31]
v_mfma_f32_16x16x32_bf16 v[8:11], a[16:19], v[80:83], v[8:11]
v_mfma_f32_16x16x32_bf16 v[12:15], a[80:83], v[80:83], v[12:15]
v_mfma_f32_16x16x32_bf16 v[16:19], a[144:147], v[80:83], v[16:19]
v_mfma_f32_16x16x32_bf16 v[20:23], a[208:211], v[80:83], v[20:23]
v_mfma_f32_16x16x32_bf16 v[24:27], v[80:83], v[144:147], v[24:27]
v_mfma_f32_16x16x32_bf16 v[28:31], v[80:83], v[208:211], v[28:31]
v_mfma_f32_16x16x32_bf16 v[8:11], a[20:23], v[84:87], v[8:11]
v_mfma_f32_16x16x32_bf16 v[12:15], a[84:87], v[84:87], v[12:15]
v_mfma_f32_16x16x32_bf16 v[16:19], a[148:151], v[84:87], v[16:19]
v_mfma_f32_16x16x32_bf16 v[20:23], a[212:215], v[84:87], v[20:23]
v_mfma_f32_16x16x32_bf16 v[24:27], v[84:87], v[148:151], v[24:27]
v_mfma_f32_16x16x32_bf16 v[28:31], v[84:87], v[212:215], v[28:31]
v_mfma_f32_16x16x32_bf16 v[8:11], a[24:27], v[88:91], v[8:11]
v_mfma_f32_16x16x32_bf16 v[12:15], a[88:91], v[88:91], v[12:15]
v_mfma_f32_16x16x32_bf16 v[16:19], a[152:155], v[88:91], v[16:19]
v_mfma_f32_16x16x32_bf16 v[20:23], a[216:219], v[88:91], v[20:23]
v_mfma_f32_16x16x32_bf16 v[24:27], v[88:91], v[152:155], v[24:27]
v_mfma_f32_16x16x32_bf16 v[28:31], v[88:91], v[216:219], v[28:31]
v_mfma_f32_16x16x32_bf16 v[8:11], a[28:31], v[92:95], v[8:11]
v_mfma_f32_16x16x32_bf16 v[12:15], a[92:95], v[92:95], v[12:15]
v_mfma_f32_16x16x32_bf16 v[16:19], a[156:159], v[92:95], v[16:19]
v_mfma_f32_16x16x32_bf16 v[20:23], a[220:223], v[92:95], v[20:23]
v_mfma_f32_16x16x32_bf16 v[24:27], v[92:95], v[156:159], v[24:27]
v_mfma_f32_16x16x32_bf16 v[28:31], v[92:95], v[220:223], v[28:31]
v_mfma_f32_16x16x32_bf16 v[8:11], a[32:35], v[96:99], v[8:11]
v_mfma_f32_16x16x32_bf16 v[12:15], a[96:99], v[96:99], v[12:15]
v_mfma_f32_16x16x32_bf16 v[16:19], a[160:163], v[96:99], v[16:19]
v_mfma_f32_16x16x32_bf16 v[20:23], a[224:227], v[96:99], v[20:23]
v_mfma_f32_16x16x32_bf16 v[24:27], v[96:99], v[160:163], v[24:27]
v_mfma_f32_16x16x32_bf16 v[28:31], v[96:99], v[224:227], v[28:31]
v_mfma_f32_16x16x32_bf16 v[8:11], a[36:39], v[100:103], v[8:11]
v_mfma_f32_16x16x32_bf16 v[12:15], a[100:103], v[100:103], v[12:15]
v_mfma_f32_16x16x32_bf16 v[16:19], a[164:167], v[100:103], v[16:19]
v_mfma_f32_16x16x32_bf16 v[20:23], a[228:231], v[100:103], v[20:23]
v_mfma_f32_16x16x32_bf16 v[24:27], v[100:103], v[164:167], v[24:27]
v_mfma_f32_16x16x32_bf16 v[28:31], v[100:103], v[228:231], v[28:31]
v_mfma_f32_16x16x32_bf16 v[8:11], a[40:43], v[104:107], v[8:11]
v_mfma_f32_16x16x32_bf16 v[12:15], a[104:107], v[104:107], v[12:15]
v_mfma_f32_16x16x32_bf16 v[16:19], a[168:171], v[104:107], v[16:19]
v_mfma_f32_16x16x32_bf16 v[20:23], a[232:235], v[104:107], v[20:23]
v_mfma_f32_16x16x32_bf16 v[24:27], v[104:107], v[168:171], v[24:27]
v_mfma_f32_16x16x32_bf16 v[28:31], v[104:107], v[232:235], v[28:31]
v_mfma_f32_16x16x32_bf16 v[8:11], a[44:47], v[108:111], v[8:11]
v_mfma_f32_16x16x32_bf16 v[12:15], a[108:111], v[108:111], v[12:15]
v_mfma_f32_16x16x32_bf16 v[16:19], a[172:175], v[108:111], v[16:19]
v_mfma_f32_16x16x32_bf16 v[20:23], a[236:239], v[108:111], v[20:23]
v_mfma_f32_16x16x32_bf16 v[24:27], v[108:111], v[172:175], v[24:27]
v_mfma_f32_16x16x32_bf16 v[28:31], v[108:111], v[236:239], v[28:31]
v_mfma_f32_16x16x32_bf16 v[8:11], a[48:51], v[112:115], v[8:11]
v_mfma_f32_16x16x32_bf16 v[12:15], a[112:115], v[112:115], v[12:15]
v_mfma_f32_16x16x32_bf16 v[16:19], a[176:179], v[112:115], v[16:19]
v_mfma_f32_16x16x32_bf16 v[20:23], a[240:243], v[112:115], v[20:23]
v_mfma_f32_16x16x32_bf16 v[24:27], v[112:115], v[176:179], v[24:27]
v_mfma_f32_16x16x32_bf16 v[28:31], v[112:115], v[240:243], v[28:31]
v_mfma_f32_16x16x32_bf16 v[8:11], a[52:55], v[116:119], v[8:11]
v_mfma_f32_16x16x32_bf16 v[12:15], a[116:119], v[116:119], v[12:15]
v_mfma_f32_16x16x32_bf16 v[16:19], a[180:183], v[116:119], v[16:19]
v_mfma_f32_16x16x32_bf16 v[20:23], a[244:247], v[116:119], v[20:23]
v_mfma_f32_16x16x32_bf16 v[24:27], v[116:119], v[180:183], v[24:27]
v_mfma_f32_16x16x32_bf16 v[28:31], v[116:119], v[244:247], v[28:31]
v_mfma_f32_16x16x32_bf16 v[8:11], a[56:59], v[120:123], v[8:11]
v_mfma_f32_16x16x32_bf16 v[12:15], a[120:123], v[120:123], v[12:15]
v_mfma_f32_16x16x32_bf16 v[16:19], a[184:187], v[120:123], v[16:19]
v_mfma_f32_16x16x32_bf16 v[20:23], a[248:251], v[120:123], v[20:23]
v_mfma_f32_16x16x32_bf16 v[24:27], v[120:123], v[184:187], v[24:27]
v_mfma_f32_16x16x32_bf16 v[28:31], v[120:123], v[248:251], v[28:31]
v_mfma_f32_16x16x32_bf16 v[8:11], a[60:63], v[124:127], v[8:11]
v_mfma_f32_16x16x32_bf16 v[12:15], a[124:127], v[124:127], v[12:15]
v_mfma_f32_16x16x32_bf16 v[16:19], a[188:191], v[124:127], v[16:19]
v_mfma_f32_16x16x32_bf16 v[20:23], a[252:255], v[124:127], v[20:23]
v_mfma_f32_16x16x32_bf16 v[24:27], v[124:127], v[188:191], v[24:27]
v_mfma_f32_16x16x32_bf16 v[28:31], v[124:127], v[252:255], v[28:31]
s_nop 15
v_cvt_pk_bf16_f32 v8, v8, v9
v_cvt_pk_bf16_f32 v9, v10, v11
v_cvt_pk_bf16_f32 v12, v12, v13
v_cvt_pk_bf16_f32 v13, v14, v15
v_cvt_pk_bf16_f32 v16, v16, v17
v_cvt_pk_bf16_f32 v17, v18, v19
v_cvt_pk_bf16_f32 v20, v20, v21
v_cvt_pk_bf16_f32 v21, v22, v23
v_cvt_pk_bf16_f32 v24, v24, v25
v_cvt_pk_bf16_f32 v25, v26, v27
v_cvt_pk_bf16_f32 v28, v28, v29
v_cvt_pk_bf16_f32 v29, v30, v31
v_mul_u32_u24 v2, 272, v62
v_lshl_add_u32 v2, v58, 3, v2
s_lshl_b32 s4, s3, 6
v_add_u32 v2, s4, v2
v_cmp_gt_u32 vcc, 8, v62
s_and_saveexec_b64 s[32:33], vcc
ds_write_b64 v2, v[8:9] offset:8320
ds_write_b64 v2, v[12:13] offset:8352
ds_write_b64 v2, v[16:17] offset:10496
ds_write_b64 v2, v[20:21] offset:10528
s_lshl_b32 s5, s30, 5
s_add_u32 s5, s5, s2
s_lshl_b32 s5, s5, 11
s_add_u32 s6, s5, 111149056
s_add_u32 s6, s6, s4
v_lshlrev_b32 v3, 8, v62
v_lshl_add_u32 v3, v58, 3, v3
buffer_store_dwordx2 v[16:17], v3, s[8:11], s6 offen
buffer_store_dwordx2 v[20:21], v3, s[8:11], s6 offen offset:32
s_mov_b64 exec, s[32:33]
s_lshl_b32 s4, s3, 9
s_add_u32 s6, s5, 115343360
s_add_u32 s6, s6, s4
v_lshlrev_b32 v3, 4, v62
v_lshl_add_u32 v3, v58, 3, v3
v_cmp_gt_u32 vcc, 2, v58
s_and_saveexec_b64 s[32:33], vcc
buffer_store_dwordx2 v[24:25], v3, s[8:11], s6 offen
buffer_store_dwordx2 v[28:29], v3, s[8:11], s6 offen offset:256
s_mov_b64 exec, s[32:33]
s_waitcnt lgkmcnt(0)
s_barrier
v_and_b32 v2, 7, v1
v_mul_u32_u24 v2, 272, v2
v_lshl_add_u32 v2, v58, 4, v2
v_mul_u32_u24 v3, 272, v62
v_lshl_add_u32 v3, v58, 4, v3
ds_read_b128 v[64:67], v2 offset:8320
ds_read_b128 v[80:83], v2 offset:10496
ds_read_b128 v[96:99], v3 offset:14848
ds_read_b128 v[112:115], v3 offset:19200
ds_read_b128 v[68:71], v2 offset:8384
ds_read_b128 v[84:87], v2 offset:10560
ds_read_b128 v[100:103], v3 offset:14912
ds_read_b128 v[116:119], v3 offset:19264
ds_read_b128 v[72:75], v2 offset:8448
ds_read_b128 v[88:91], v2 offset:10624
ds_read_b128 v[104:107], v3 offset:14976
ds_read_b128 v[120:123], v3 offset:19328
ds_read_b128 v[76:79], v2 offset:8512
ds_read_b128 v[92:95], v2 offset:10688
ds_read_b128 v[108:111], v3 offset:15040
ds_read_b128 v[124:127], v3 offset:19392
s_lshl_b32 s4, s3, 5
v_add_u32 v4, s4, v62
v_mul_u32_u24 v4, 72, v4
v_lshl_add_u32 v4, v58, 3, v4
ds_read_b64 v[32:33], v4 offset:23552
ds_read_b64 v[34:35], v4 offset:23584
ds_read_b64 v[36:37], v4 offset:24704
ds_read_b64 v[38:39], v4 offset:24736
v_mov_b32 v8, 0
v_mov_b32 v9, 0
v_mov_b32 v10, 0
v_mov_b32 v11, 0
v_mov_b32 v12, 0
v_mov_b32 v13, 0
v_mov_b32 v14, 0
v_mov_b32 v15, 0
v_mov_b32 v16, 0
v_mov_b32 v17, 0
v_mov_b32 v18, 0
v_mov_b32 v19, 0
s_waitcnt lgkmcnt(0)
v_mfma_f32_16x16x32_bf16 v[8:11], v[96:99], v[64:67], v[8:11]
v_mfma_f32_16x16x32_bf16 v[8:11], v[100:103], v[68:71], v[8:11]
v_mfma_f32_16x16x32_bf16 v[8:11], v[104:107], v[72:75], v[8:11]
v_mfma_f32_16x16x32_bf16 v[8:11], v[108:111], v[76:79], v[8:11]
v_mfma_f32_16x16x32_bf16 v[12:15], v[112:115], v[64:67], v[12:15]
v_mfma_f32_16x16x32_bf16 v[12:15], v[116:119], v[68:71], v[12:15]
v_mfma_f32_16x16x32_bf16 v[12:15], v[120:123], v[72:75], v[12:15]
v_mfma_f32_16x16x32_bf16 v[12:15], v[124:127], v[76:79], v[12:15]
v_mfma_f32_16x16x32_bf16 v[16:19], v[80:83], v[64:67], v[16:19]
v_mfma_f32_16x16x32_bf16 v[16:19], v[84:87], v[68:71], v[16:19]
v_mfma_f32_16x16x32_bf16 v[16:19], v[88:91], v[72:75], v[16:19]
v_mfma_f32_16x16x32_bf16 v[16:19], v[92:95], v[76:79], v[16:19]
s_nop 15
v_cvt_pk_bf16_f32 v8, v8, v8
v_lshlrev_b32 v8, 16, v8
v_mul_f32 v8, 0x3db504f3, v8
v_cvt_pk_bf16_f32 v8, v8, v8
v_lshlrev_b32 v8, 16, v8
v_cvt_pk_bf16_f32 v9, v9, v9
v_lshlrev_b32 v9, 16, v9
v_mul_f32 v9, 0x3db504f3, v9
v_cvt_pk_bf16_f32 v9, v9, v9
v_lshlrev_b32 v9, 16, v9
v_cvt_pk_bf16_f32 v10, v10, v10
v_lshlrev_b32 v10, 16, v10
v_mul_f32 v10, 0x3db504f3, v10
v_cvt_pk_bf16_f32 v10, v10, v10
v_lshlrev_b32 v10, 16, v10
v_cvt_pk_bf16_f32 v11, v11, v11
v_lshlrev_b32 v11, 16, v11
v_mul_f32 v11, 0x3db504f3, v11
v_cvt_pk_bf16_f32 v11, v11, v11
v_lshlrev_b32 v11, 16, v11
v_cvt_pk_bf16_f32 v12, v12, v12
v_lshlrev_b32 v12, 16, v12
v_mul_f32 v12, 0x3db504f3, v12
v_cvt_pk_bf16_f32 v12, v12, v12
v_lshlrev_b32 v12, 16, v12
v_cvt_pk_bf16_f32 v13, v13, v13
v_lshlrev_b32 v13, 16, v13
v_mul_f32 v13, 0x3db504f3, v13
v_cvt_pk_bf16_f32 v13, v13, v13
v_lshlrev_b32 v13, 16, v13
v_cvt_pk_bf16_f32 v14, v14, v14
v_lshlrev_b32 v14, 16, v14
v_mul_f32 v14, 0x3db504f3, v14
v_cvt_pk_bf16_f32 v14, v14, v14
v_lshlrev_b32 v14, 16, v14
v_cvt_pk_bf16_f32 v15, v15, v15
v_lshlrev_b32 v15, 16, v15
v_mul_f32 v15, 0x3db504f3, v15
v_cvt_pk_bf16_f32 v15, v15, v15
v_lshlrev_b32 v15, 16, v15
v_cvt_pk_bf16_f32 v16, v16, v16
v_lshlrev_b32 v16, 16, v16
v_mul_f32 v16, 0x3db504f3, v16
v_cvt_pk_bf16_f32 v16, v16, v16
v_lshlrev_b32 v16, 16, v16
v_cvt_pk_bf16_f32 v17, v17, v17
v_lshlrev_b32 v17, 16, v17
v_mul_f32 v17, 0x3db504f3, v17
v_cvt_pk_bf16_f32 v17, v17, v17
v_lshlrev_b32 v17, 16, v17
v_cvt_pk_bf16_f32 v18, v18, v18
v_lshlrev_b32 v18, 16, v18
v_mul_f32 v18, 0x3db504f3, v18
v_cvt_pk_bf16_f32 v18, v18, v18
v_lshlrev_b32 v18, 16, v18
v_cvt_pk_bf16_f32 v19, v19, v19
v_lshlrev_b32 v19, 16, v19
v_mul_f32 v19, 0x3db504f3, v19
v_cvt_pk_bf16_f32 v19, v19, v19
v_lshlrev_b32 v19, 16, v19
v_add_u32 v60, 0, v61
v_cmp_gt_u32 vcc, v60, v57
s_nop 1
v_cndmask_b32 v16, v16, v59, vcc
v_add_u32 v60, 1, v61
v_cmp_gt_u32 vcc, v60, v57
s_nop 1
v_cndmask_b32 v17, v17, v59, vcc
v_add_u32 v60, 2, v61
v_cmp_gt_u32 vcc, v60, v57
s_nop 1
v_cndmask_b32 v18, v18, v59, vcc
v_add_u32 v60, 3, v61
v_cmp_gt_u32 vcc, v60, v57
s_nop 1
v_cndmask_b32 v19, v19, v59, vcc
v_max_f32 v40, v8, v9
v_max_f32 v40, v40, v10
v_max_f32 v40, v40, v11
v_max_f32 v40, v40, v12
v_max_f32 v40, v40, v13
v_max_f32 v40, v40, v14
v_max_f32 v40, v40, v15
v_max_f32 v40, v40, v16
v_max_f32 v40, v40, v17
v_max_f32 v40, v40, v18
v_max_f32 v40, v40, v19
v_xor_b32 v41, 64, v63
ds_bpermute_b32 v42, v41, v40
s_waitcnt lgkmcnt(0)
v_max_f32 v40, v40, v42
v_xor_b32 v41, 128, v63
ds_bpermute_b32 v42, v41, v40
s_waitcnt lgkmcnt(0)
v_max_f32 v40, v40, v42
v_mov_b32 v43, 0
v_sub_f32 v8, v8, v40
v_mul_f32 v8, 0x3fb8aa3b, v8
v_exp_f32 v8, v8
s_nop 0
v_add_f32 v43, v43, v8
v_sub_f32 v9, v9, v40
v_mul_f32 v9, 0x3fb8aa3b, v9
v_exp_f32 v9, v9
s_nop 0
v_add_f32 v43, v43, v9
v_sub_f32 v10, v10, v40
v_mul_f32 v10, 0x3fb8aa3b, v10
v_exp_f32 v10, v10
s_nop 0
v_add_f32 v43, v43, v10
v_sub_f32 v11, v11, v40
v_mul_f32 v11, 0x3fb8aa3b, v11
v_exp_f32 v11, v11
s_nop 0
v_add_f32 v43, v43, v11
v_sub_f32 v12, v12, v40
v_mul_f32 v12, 0x3fb8aa3b, v12
v_exp_f32 v12, v12
s_nop 0
v_add_f32 v43, v43, v12
v_sub_f32 v13, v13, v40
v_mul_f32 v13, 0x3fb8aa3b, v13
v_exp_f32 v13, v13
s_nop 0
v_add_f32 v43, v43, v13
v_sub_f32 v14, v14, v40
v_mul_f32 v14, 0x3fb8aa3b, v14
v_exp_f32 v14, v14
s_nop 0
v_add_f32 v43, v43, v14
v_sub_f32 v15, v15, v40
v_mul_f32 v15, 0x3fb8aa3b, v15
v_exp_f32 v15, v15
s_nop 0
v_add_f32 v43, v43, v15
v_sub_f32 v16, v16, v40
v_mul_f32 v16, 0x3fb8aa3b, v16
v_exp_f32 v16, v16
s_nop 0
v_add_f32 v43, v43, v16
v_sub_f32 v17, v17, v40
v_mul_f32 v17, 0x3fb8aa3b, v17
v_exp_f32 v17, v17
s_nop 0
v_add_f32 v43, v43, v17
v_sub_f32 v18, v18, v40
v_mul_f32 v18, 0x3fb8aa3b, v18
v_exp_f32 v18, v18
s_nop 0
v_add_f32 v43, v43, v18
v_sub_f32 v19, v19, v40
v_mul_f32 v19, 0x3fb8aa3b, v19
v_exp_f32 v19, v19
s_nop 0
v_add_f32 v43, v43, v19
v_xor_b32 v41, 64, v63
ds_bpermute_b32 v42, v41, v43
s_waitcnt lgkmcnt(0)
v_add_f32 v43, v43, v42
v_xor_b32 v41, 128, v63
ds_bpermute_b32 v42, v41, v43
s_waitcnt lgkmcnt(0)
v_add_f32 v43, v43, v42
v_rcp_f32 v43, v43
s_nop 0
v_mul_f32 v8, v8, v43
v_mul_f32 v9, v9, v43
v_mul_f32 v10, v10, v43
v_mul_f32 v11, v11, v43
v_mul_f32 v12, v12, v43
v_mul_f32 v13, v13, v43
v_mul_f32 v14, v14, v43
v_mul_f32 v15, v15, v43
v_mul_f32 v16, v16, v43
v_mul_f32 v17, v17, v43
v_mul_f32 v18, v18, v43
v_mul_f32 v19, v19, v43
v_cvt_pk_bf16_f32 v8, v8, v9
v_cvt_pk_bf16_f32 v9, v10, v11
v_cvt_pk_bf16_f32 v12, v12, v13
v_cvt_pk_bf16_f32 v13, v14, v15
v_cvt_pk_bf16_f32 v16, v16, v17
v_cvt_pk_bf16_f32 v17, v18, v19
v_mov_b32 v48, 0
v_mov_b32 v49, 0
v_mov_b32 v50, 0
v_mov_b32 v51, 0
v_mov_b32 v52, 0
v_mov_b32 v53, 0
v_mov_b32 v54, 0
v_mov_b32 v55, 0
s_nop 1
v_mfma_f32_16x16x16_bf16 v[48:51], v[32:33], v[8:9], v[48:51]
v_mfma_f32_16x16x16_bf16 v[48:51], v[34:35], v[12:13], v[48:51]
v_mfma_f32_16x16x16_bf16 v[48:51], v[24:25], v[16:17], v[48:51]
v_mfma_f32_16x16x16_bf16 v[52:55], v[36:37], v[8:9], v[52:55]
v_mfma_f32_16x16x16_bf16 v[52:55], v[38:39], v[12:13], v[52:55]
v_mfma_f32_16x16x16_bf16 v[52:55], v[28:29], v[16:17], v[52:55]
s_nop 15
v_cvt_pk_bf16_f32 v48, v48, v49
v_cvt_pk_bf16_f32 v49, v50, v51
v_cvt_pk_bf16_f32 v52, v52, v53
v_cvt_pk_bf16_f32 v53, v54, v55
v_mul_u32_u24 v2, 272, v62
v_lshl_add_u32 v2, v58, 3, v2
s_lshl_b32 s4, s3, 6
v_add_u32 v2, s4, v2
v_cmp_gt_u32 vcc, 8, v62
s_and_saveexec_b64 s[32:33], vcc
ds_write_b64 v2, v[48:49] offset:12672
ds_write_b64 v2, v[52:53] offset:12704
s_mov_b64 exec, s[32:33]
s_waitcnt lgkmcnt(0)
s_barrier
v_and_b32 v2, 7, v1
v_mul_u32_u24 v2, 272, v2
v_lshl_add_u32 v2, v58, 4, v2
s_lshl_b32 s4, s3, 15
s_add_u32 s4, s4, 32768
v_add_u32 v3, s4, v56
ds_read_b128 v[64:67], v2 offset:12672
ds_read_b128 v[68:71], v2 offset:12736
ds_read_b128 v[72:75], v2 offset:12800
ds_read_b128 v[76:79], v2 offset:12864
v_lshlrev_b32 v4, 7, v62
v_lshl_add_u32 v4, v58, 5, v4
s_lshl_b32 s5, s2, 10
s_lshl_b32 s6, s3, 18
s_add_u32 s5, s5, s6
s_add_u32 s5, s5, 119537664
s_add_u32 s31, s30, 1
v_cmp_gt_u32 vcc, 8, v62
ds_read_b128 v[80:83], v3 offset:0
ds_read_b128 v[84:87], v3 offset:1024
ds_read_b128 v[88:91], v3 offset:2048
ds_read_b128 v[92:95], v3 offset:3072
v_mov_b32 v8, 0
v_mov_b32 v9, 0
v_mov_b32 v10, 0
v_mov_b32 v11, 0
s_waitcnt lgkmcnt(0)
v_mfma_f32_16x16x32_bf16 v[8:11], v[80:83], v[64:67], v[8:11]
v_mfma_f32_16x16x32_bf16 v[8:11], v[84:87], v[68:71], v[8:11]
v_mfma_f32_16x16x32_bf16 v[8:11], v[88:91], v[72:75], v[8:11]
v_mfma_f32_16x16x32_bf16 v[8:11], v[92:95], v[76:79], v[8:11]
s_nop 15
v_mov_b32 v12, v8
v_mov_b32 v13, s31
v_mov_b32 v14, v9
v_mov_b32 v15, s31
v_mov_b32 v16, v10
v_mov_b32 v17, s31
v_mov_b32 v18, v11
v_mov_b32 v19, s31
s_and_saveexec_b64 s[32:33], vcc
buffer_store_dwordx4 v[12:15], v4, s[8:11], s5 offen sc1
buffer_store_dwordx4 v[16:19], v4, s[8:11], s5 offen offset:16 sc1
s_mov_b64 exec, s[32:33]
s_add_u32 s5, s5, 32768
s_nop 1
ds_read_b128 v[80:83], v3 offset:4096
ds_read_b128 v[84:87], v3 offset:5120
ds_read_b128 v[88:91], v3 offset:6144
ds_read_b128 v[92:95], v3 offset:7168
v_mov_b32 v8, 0
v_mov_b32 v9, 0
v_mov_b32 v10, 0
v_mov_b32 v11, 0
s_waitcnt lgkmcnt(0)
v_mfma_f32_16x16x32_bf16 v[8:11], v[80:83], v[64:67], v[8:11]
v_mfma_f32_16x16x32_bf16 v[8:11], v[84:87], v[68:71], v[8:11]
v_mfma_f32_16x16x32_bf16 v[8:11], v[88:91], v[72:75], v[8:11]
v_mfma_f32_16x16x32_bf16 v[8:11], v[92:95], v[76:79], v[8:11]
s_nop 15
v_mov_b32 v12, v8
v_mov_b32 v13, s31
v_mov_b32 v14, v9
v_mov_b32 v15, s31
v_mov_b32 v16, v10
v_mov_b32 v17, s31
v_mov_b32 v18, v11
v_mov_b32 v19, s31
s_and_saveexec_b64 s[32:33], vcc
buffer_store_dwordx4 v[12:15], v4, s[8:11], s5 offen sc1
buffer_store_dwordx4 v[16:19], v4, s[8:11], s5 offen offset:16 sc1
s_mov_b64 exec, s[32:33]
s_add_u32 s5, s5, 32768
s_nop 1
ds_read_b128 v[80:83], v3 offset:8192
ds_read_b128 v[84:87], v3 offset:9216
ds_read_b128 v[88:91], v3 offset:10240
ds_read_b128 v[92:95], v3 offset:11264
v_mov_b32 v8, 0
v_mov_b32 v9, 0
v_mov_b32 v10, 0
v_mov_b32 v11, 0
s_waitcnt lgkmcnt(0)
v_mfma_f32_16x16x32_bf16 v[8:11], v[80:83], v[64:67], v[8:11]
v_mfma_f32_16x16x32_bf16 v[8:11], v[84:87], v[68:71], v[8:11]
v_mfma_f32_16x16x32_bf16 v[8:11], v[88:91], v[72:75], v[8:11]
v_mfma_f32_16x16x32_bf16 v[8:11], v[92:95], v[76:79], v[8:11]
s_nop 15
v_mov_b32 v12, v8
v_mov_b32 v13, s31
v_mov_b32 v14, v9
v_mov_b32 v15, s31
v_mov_b32 v16, v10
v_mov_b32 v17, s31
v_mov_b32 v18, v11
v_mov_b32 v19, s31
s_and_saveexec_b64 s[32:33], vcc
buffer_store_dwordx4 v[12:15], v4, s[8:11], s5 offen sc1
buffer_store_dwordx4 v[16:19], v4, s[8:11], s5 offen offset:16 sc1
s_mov_b64 exec, s[32:33]
s_add_u32 s5, s5, 32768
s_nop 1
ds_read_b128 v[80:83], v3 offset:12288
ds_read_b128 v[84:87], v3 offset:13312
ds_read_b128 v[88:91], v3 offset:14336
ds_read_b128 v[92:95], v3 offset:15360
v_mov_b32 v8, 0
v_mov_b32 v9, 0
v_mov_b32 v10, 0
v_mov_b32 v11, 0
s_waitcnt lgkmcnt(0)
v_mfma_f32_16x16x32_bf16 v[8:11], v[80:83], v[64:67], v[8:11]
v_mfma_f32_16x16x32_bf16 v[8:11], v[84:87], v[68:71], v[8:11]
v_mfma_f32_16x16x32_bf16 v[8:11], v[88:91], v[72:75], v[8:11]
v_mfma_f32_16x16x32_bf16 v[8:11], v[92:95], v[76:79], v[8:11]
s_nop 15
v_mov_b32 v12, v8
v_mov_b32 v13, s31
v_mov_b32 v14, v9
v_mov_b32 v15, s31
v_mov_b32 v16, v10
v_mov_b32 v17, s31
v_mov_b32 v18, v11
v_mov_b32 v19, s31
s_and_saveexec_b64 s[32:33], vcc
buffer_store_dwordx4 v[12:15], v4, s[8:11], s5 offen sc1
buffer_store_dwordx4 v[16:19], v4, s[8:11], s5 offen offset:16 sc1
s_mov_b64 exec, s[32:33]
s_add_u32 s5, s5, 32768
s_nop 1
ds_read_b128 v[80:83], v3 offset:16384
ds_read_b128 v[84:87], v3 offset:17408
ds_read_b128 v[88:91], v3 offset:18432
ds_read_b128 v[92:95], v3 offset:19456
v_mov_b32 v8, 0
v_mov_b32 v9, 0
v_mov_b32 v10, 0
v_mov_b32 v11, 0
s_waitcnt lgkmcnt(0)
v_mfma_f32_16x16x32_bf16 v[8:11], v[80:83], v[64:67], v[8:11]
v_mfma_f32_16x16x32_bf16 v[8:11], v[84:87], v[68:71], v[8:11]
v_mfma_f32_16x16x32_bf16 v[8:11], v[88:91], v[72:75], v[8:11]
v_mfma_f32_16x16x32_bf16 v[8:11], v[92:95], v[76:79], v[8:11]
s_nop 15
v_mov_b32 v12, v8
v_mov_b32 v13, s31
v_mov_b32 v14, v9
v_mov_b32 v15, s31
v_mov_b32 v16, v10
v_mov_b32 v17, s31
v_mov_b32 v18, v11
v_mov_b32 v19, s31
s_and_saveexec_b64 s[32:33], vcc
buffer_store_dwordx4 v[12:15], v4, s[8:11], s5 offen sc1
buffer_store_dwordx4 v[16:19], v4, s[8:11], s5 offen offset:16 sc1
s_mov_b64 exec, s[32:33]
s_add_u32 s5, s5, 32768
s_nop 1
ds_read_b128 v[80:83], v3 offset:20480
ds_read_b128 v[84:87], v3 offset:21504
ds_read_b128 v[88:91], v3 offset:22528
ds_read_b128 v[92:95], v3 offset:23552
v_mov_b32 v8, 0
v_mov_b32 v9, 0
v_mov_b32 v10, 0
v_mov_b32 v11, 0
s_waitcnt lgkmcnt(0)
v_mfma_f32_16x16x32_bf16 v[8:11], v[80:83], v[64:67], v[8:11]
v_mfma_f32_16x16x32_bf16 v[8:11], v[84:87], v[68:71], v[8:11]
v_mfma_f32_16x16x32_bf16 v[8:11], v[88:91], v[72:75], v[8:11]
v_mfma_f32_16x16x32_bf16 v[8:11], v[92:95], v[76:79], v[8:11]
s_nop 15
v_mov_b32 v12, v8
v_mov_b32 v13, s31
v_mov_b32 v14, v9
v_mov_b32 v15, s31
v_mov_b32 v16, v10
v_mov_b32 v17, s31
v_mov_b32 v18, v11
v_mov_b32 v19, s31
s_and_saveexec_b64 s[32:33], vcc
buffer_store_dwordx4 v[12:15], v4, s[8:11], s5 offen sc1
buffer_store_dwordx4 v[16:19], v4, s[8:11], s5 offen offset:16 sc1
s_mov_b64 exec, s[32:33]
s_add_u32 s5, s5, 32768
s_nop 1
ds_read_b128 v[80:83], v3 offset:24576
ds_read_b128 v[84:87], v3 offset:25600
ds_read_b128 v[88:91], v3 offset:26624
ds_read_b128 v[92:95], v3 offset:27648
v_mov_b32 v8, 0
v_mov_b32 v9, 0
v_mov_b32 v10, 0
v_mov_b32 v11, 0
s_waitcnt lgkmcnt(0)
v_mfma_f32_16x16x32_bf16 v[8:11], v[80:83], v[64:67], v[8:11]
v_mfma_f32_16x16x32_bf16 v[8:11], v[84:87], v[68:71], v[8:11]
v_mfma_f32_16x16x32_bf16 v[8:11], v[88:91], v[72:75], v[8:11]
v_mfma_f32_16x16x32_bf16 v[8:11], v[92:95], v[76:79], v[8:11]
s_nop 15
v_mov_b32 v12, v8
v_mov_b32 v13, s31
v_mov_b32 v14, v9
v_mov_b32 v15, s31
v_mov_b32 v16, v10
v_mov_b32 v17, s31
v_mov_b32 v18, v11
v_mov_b32 v19, s31
s_and_saveexec_b64 s[32:33], vcc
buffer_store_dwordx4 v[12:15], v4, s[8:11], s5 offen sc1
buffer_store_dwordx4 v[16:19], v4, s[8:11], s5 offen offset:16 sc1
s_mov_b64 exec, s[32:33]
s_add_u32 s5, s5, 32768
s_nop 1
ds_read_b128 v[80:83], v3 offset:28672
ds_read_b128 v[84:87], v3 offset:29696
ds_read_b128 v[88:91], v3 offset:30720
ds_read_b128 v[92:95], v3 offset:31744
v_mov_b32 v8, 0
v_mov_b32 v9, 0
v_mov_b32 v10, 0
v_mov_b32 v11, 0
s_waitcnt lgkmcnt(0)
v_mfma_f32_16x16x32_bf16 v[8:11], v[80:83], v[64:67], v[8:11]
v_mfma_f32_16x16x32_bf16 v[8:11], v[84:87], v[68:71], v[8:11]
v_mfma_f32_16x16x32_bf16 v[8:11], v[88:91], v[72:75], v[8:11]
v_mfma_f32_16x16x32_bf16 v[8:11], v[92:95], v[76:79], v[8:11]
s_nop 15
v_mov_b32 v12, v8
v_mov_b32 v13, s31
v_mov_b32 v14, v9
v_mov_b32 v15, s31
v_mov_b32 v16, v10
v_mov_b32 v17, s31
v_mov_b32 v18, v11
v_mov_b32 v19, s31
s_and_saveexec_b64 s[32:33], vcc
buffer_store_dwordx4 v[12:15], v4, s[8:11], s5 offen sc1
buffer_store_dwordx4 v[16:19], v4, s[8:11], s5 offen offset:16 sc1
s_mov_b64 exec, s[32:33]
s_add_u32 s5, s5, 32768
s_nop 1
s_cmp_eq_u32 s30, 63
s_cbranch_scc1 Lend_chain
s_lshl_b32 s5, s2, 15
s_lshl_b32 s6, s3, 13
s_add_u32 s5, s5, s6
s_add_u32 s5, s5, 119537664
Lpoll1:
buffer_load_dwordx4 v[8:11], v56, s[8:11], s5 offen offset:0 sc1
buffer_load_dwordx4 v[12:15], v56, s[8:11], s5 offen offset:1024 sc1
buffer_load_dwordx4 v[16:19], v56, s[8:11], s5 offen offset:2048 sc1
buffer_load_dwordx4 v[20:23], v56, s[8:11], s5 offen offset:3072 sc1
s_add_u32 s6, s5, 4096
buffer_load_dwordx4 v[24:27], v56, s[8:11], s6 offen sc1
s_add_u32 s6, s5, 5120
buffer_load_dwordx4 v[28:31], v56, s[8:11], s6 offen sc1
s_add_u32 s6, s5, 6144
buffer_load_dwordx4 v[32:35], v56, s[8:11], s6 offen sc1
s_add_u32 s6, s5, 7168
buffer_load_dwordx4 v[36:39], v56, s[8:11], s6 offen sc1
s_waitcnt vmcnt(0)
v_xor_b32 v3, s31, v9
v_xor_b32 v2, s31, v11
v_or_b32 v3, v3, v2
v_xor_b32 v2, s31, v13
v_or_b32 v3, v3, v2
v_xor_b32 v2, s31, v15
v_or_b32 v3, v3, v2
v_xor_b32 v2, s31, v17
v_or_b32 v3, v3, v2
v_xor_b32 v2, s31, v19
v_or_b32 v3, v3, v2
v_xor_b32 v2, s31, v21
v_or_b32 v3, v3, v2
v_xor_b32 v2, s31, v23
v_or_b32 v3, v3, v2
v_xor_b32 v2, s31, v25
v_or_b32 v3, v3, v2
v_xor_b32 v2, s31, v27
v_or_b32 v3, v3, v2
v_xor_b32 v2, s31, v29
v_or_b32 v3, v3, v2
v_xor_b32 v2, s31, v31
v_or_b32 v3, v3, v2
v_xor_b32 v2, s31, v33
v_or_b32 v3, v3, v2
v_xor_b32 v2, s31, v35
v_or_b32 v3, v3, v2
v_xor_b32 v2, s31, v37
v_or_b32 v3, v3, v2
v_xor_b32 v2, s31, v39
v_or_b32 v3, v3, v2
v_cmp_ne_u32 vcc, 0, v3
s_cbranch_vccnz Lpoll1
v_add_f32 v8, v8, v12
v_add_f32 v10, v10, v14
v_add_f32 v8, v8, v16
v_add_f32 v10, v10, v18
v_add_f32 v8, v8, v20
v_add_f32 v10, v10, v22
v_add_f32 v8, v8, v24
v_add_f32 v10, v10, v26
v_add_f32 v8, v8, v28
v_add_f32 v10, v10, v30
v_add_f32 v8, v8, v32
v_add_f32 v10, v10, v34
v_add_f32 v8, v8, v36
v_add_f32 v10, v10, v38
v_mov_b32 v9, v10
v_lshlrev_b32 v2, 3, v0
ds_write_b64 v2, v[8:9] offset:8320
s_waitcnt lgkmcnt(0)
s_barrier
s_cmp_lg_u32 s3, 0
s_cbranch_scc1 Lnopub
ds_read_b64 v[10:11], v2 offset:8832
ds_read_b64 v[12:13], v2 offset:9344
ds_read_b64 v[14:15], v2 offset:9856
s_waitcnt lgkmcnt(0)
v_add_f32 v8, v8, v10
v_add_f32 v9, v9, v11
v_add_f32 v8, v8, v12
v_add_f32 v9, v9, v13
v_add_f32 v8, v8, v14
v_add_f32 v9, v9, v15
v_cvt_pk_bf16_f32 v8, v8, v9
v_mov_b32 v9, s31
s_lshl_b32 s5, s2, 9
s_add_u32 s5, s5, 120586240
buffer_store_dwordx2 v[8:9], v2, s[8:11], s5 offen sc1
Lnopub:
s_add_u32 s30, s30, 1
s_branch Lstep
Lend_chain:
s_endpgm
.p2align 8
.globl attn_kernel
.type attn_kernel,@function
attn_kernel:
s_load_dwordx2 s[8:9], s[0:1], 112
s_waitcnt lgkmcnt(0)
s_mov_b32 s10, 268435456
s_mov_b32 s11, 0x00020000
s_cmpk_ge_u32 s2, 512
s_cbranch_scc1 Lend_attn
v_lshrrev_b32 v2, 6, v0
s_nop 0
v_readfirstlane_b32 s3, v2
v_and_b32 v1, 63, v0
s_lshl_b32 s4, s2, 2
s_add_u32 s4, s4, s3
s_lshr_b32 s5, s4, 5
s_and_b32 s6, s4, 31
v_lshlrev_b32 v63, 2, v1
v_and_b32 v62, 15, v1
v_lshrrev_b32 v58, 4, v1
v_lshlrev_b32 v61, 2, v58
v_mov_b32 v59, 0xce6e6b28
v_mov_b32 v57, 7
v_lshlrev_b32 v2, 13, v62
v_lshl_add_u32 v2, v58, 4, v2
s_lshl_b32 s7, s5, 18
s_lshl_b32 s16, s6, 8
s_add_u32 s7, s7, s16
s_add_u32 s16, s7, 33554432
s_add_u32 s17, s7, 50331648
s_add_u32 s18, s16, 131072
s_add_u32 s19, s17, 131072
buffer_load_dwordx4 v[64:67], v2, s[8:11], s16 offen offset:0
buffer_load_dwordx4 v[80:83], v2, s[8:11], s18 offen offset:0
buffer_load_dwordx4 v[96:99], v2, s[8:11], s17 offen offset:0
buffer_load_dwordx4 v[112:115], v2, s[8:11], s19 offen offset:0
buffer_load_dwordx4 v[68:71], v2, s[8:11], s16 offen offset:64
buffer_load_dwordx4 v[84:87], v2, s[8:11], s18 offen offset:64
buffer_load_dwordx4 v[100:103], v2, s[8:11], s17 offen offset:64
buffer_load_dwordx4 v[116:119], v2, s[8:11], s19 offen offset:64
buffer_load_dwordx4 v[72:75], v2, s[8:11], s16 offen offset:128
buffer_load_dwordx4 v[88:91], v2, s[8:11], s18 offen offset:128
buffer_load_dwordx4 v[104:107], v2, s[8:11], s17 offen offset:128
buffer_load_dwordx4 v[120:123], v2, s[8:11], s19 offen offset:128
buffer_load_dwordx4 v[76:79], v2, s[8:11], s16 offen offset:192
buffer_load_dwordx4 v[92:95], v2, s[8:11], s18 offen offset:192
buffer_load_dwordx4 v[108:111], v2, s[8:11], s17 offen offset:192
buffer_load_dwordx4 v[124:127], v2, s[8:11], s19 offen offset:192
v_and_b32 v3, 7, v1
v_lshlrev_b32 v3, 8, v3
v_lshl_add_u32 v3, v58, 4, v3
s_lshl_b32 s20, s4, 11
s_add_u32 s21, s20, 111149056
s_add_u32 s22, s20, 115343360
s_lshl_b32 s23, s4, 13
s_add_u32 s23, s23, 67108864
buffer_load_dwordx4 v[128:131], v3, s[8:11], s21 offen offset:0
buffer_load_dwordx4 v[132:135], v3, s[8:11], s21 offen offset:64
buffer_load_dwordx4 v[136:139], v3, s[8:11], s21 offen offset:128
buffer_load_dwordx4 v[140:143], v3, s[8:11], s21 offen offset:192
v_lshlrev_b32 v4, 6, v62
v_lshl_add_u32 v4, v58, 3, v4
v_and_b32 v5, 1, v58
v_lshlrev_b32 v6, 4, v62
v_lshl_add_u32 v5, v5, 3, v6
buffer_load_dwordx2 v[144:145], v4, s[8:11], s23 offen
buffer_load_dwordx2 v[146:147], v4, s[8:11], s23 offen offset:32
s_add_u32 s23, s23, 1024
buffer_load_dwordx2 v[148:149], v5, s[8:11], s22 offen offset:0
buffer_load_dwordx2 v[150:151], v4, s[8:11], s23 offen
buffer_load_dwordx2 v[152:153], v4, s[8:11], s23 offen offset:32
s_add_u32 s23, s23, 1024
buffer_load_dwordx2 v[154:155], v5, s[8:11], s22 offen offset:256
buffer_load_dwordx2 v[156:157], v4, s[8:11], s23 offen
buffer_load_dwordx2 v[158:159], v4, s[8:11], s23 offen offset:32
s_add_u32 s23, s23, 1024
buffer_load_dwordx2 v[160:161], v5, s[8:11], s22 offen offset:512
buffer_load_dwordx2 v[162:163], v4, s[8:11], s23 offen
buffer_load_dwordx2 v[164:165], v4, s[8:11], s23 offen offset:32
s_add_u32 s23, s23, 1024
buffer_load_dwordx2 v[166:167], v5, s[8:11], s22 offen offset:768
buffer_load_dwordx2 v[168:169], v4, s[8:11], s23 offen
buffer_load_dwordx2 v[170:171], v4, s[8:11], s23 offen offset:32
s_add_u32 s23, s23, 1024
buffer_load_dwordx2 v[172:173], v5, s[8:11], s22 offen offset:1024
buffer_load_dwordx2 v[174:175], v4, s[8:11], s23 offen
buffer_load_dwordx2 v[176:177], v4, s[8:11], s23 offen offset:32
s_add_u32 s23, s23, 1024
buffer_load_dwordx2 v[178:179], v5, s[8:11], s22 offen offset:1280
buffer_load_dwordx2 v[180:181], v4, s[8:11], s23 offen
buffer_load_dwordx2 v[182:183], v4, s[8:11], s23 offen offset:32
s_add_u32 s23, s23, 1024
buffer_load_dwordx2 v[184:185], v5, s[8:11], s22 offen offset:1536
buffer_load_dwordx2 v[186:187], v4, s[8:11], s23 offen
buffer_load_dwordx2 v[188:189], v4, s[8:11], s23 offen offset:32
s_add_u32 s23, s23, 1024
buffer_load_dwordx2 v[190:191], v5, s[8:11], s22 offen offset:1792
v_mov_b32 v8, 0
v_mov_b32 v9, 0
v_mov_b32 v10, 0
v_mov_b32 v11, 0
v_mov_b32 v12, 0
v_mov_b32 v13, 0
v_mov_b32 v14, 0
v_mov_b32 v15, 0
v_mov_b32 v16, 0
v_mov_b32 v17, 0
v_mov_b32 v18, 0
v_mov_b32 v19, 0
v_mov_b32 v20, 0
v_mov_b32 v21, 0
v_mov_b32 v22, 0
v_mov_b32 v23, 0
v_mov_b32 v24, 0
v_mov_b32 v25, 0
v_mov_b32 v26, 0
v_mov_b32 v27, 0
s_waitcnt vmcnt(24)
v_mfma_f32_16x16x32_bf16 v[8:11], v[96:99], v[64:67], v[8:11]
v_mfma_f32_16x16x32_bf16 v[8:11], v[100:103], v[68:71], v[8:11]
v_mfma_f32_16x16x32_bf16 v[8:11], v[104:107], v[72:75], v[8:11]
v_mfma_f32_16x16x32_bf16 v[8:11], v[108:111], v[76:79], v[8:11]
v_mfma_f32_16x16x32_bf16 v[12:15], v[128:131], v[64:67], v[12:15]
v_mfma_f32_16x16x32_bf16 v[12:15], v[132:135], v[68:71], v[12:15]
v_mfma_f32_16x16x32_bf16 v[12:15], v[136:139], v[72:75], v[12:15]
v_mfma_f32_16x16x32_bf16 v[12:15], v[140:143], v[76:79], v[12:15]
v_mfma_f32_16x16x32_bf16 v[16:19], v[96:99], v[80:83], v[16:19]
v_mfma_f32_16x16x32_bf16 v[16:19], v[100:103], v[84:87], v[16:19]
v_mfma_f32_16x16x32_bf16 v[16:19], v[104:107], v[88:91], v[16:19]
v_mfma_f32_16x16x32_bf16 v[16:19], v[108:111], v[92:95], v[16:19]
v_mfma_f32_16x16x32_bf16 v[20:23], v[112:115], v[80:83], v[20:23]
v_mfma_f32_16x16x32_bf16 v[20:23], v[116:119], v[84:87], v[20:23]
v_mfma_f32_16x16x32_bf16 v[20:23], v[120:123], v[88:91], v[20:23]
v_mfma_f32_16x16x32_bf16 v[20:23], v[124:127], v[92:95], v[20:23]
v_mfma_f32_16x16x32_bf16 v[24:27], v[128:131], v[80:83], v[24:27]
v_mfma_f32_16x16x32_bf16 v[24:27], v[132:135], v[84:87], v[24:27]
v_mfma_f32_16x16x32_bf16 v[24:27], v[136:139], v[88:91], v[24:27]
v_mfma_f32_16x16x32_bf16 v[24:27], v[140:143], v[92:95], v[24:27]
s_nop 15
v_cvt_pk_bf16_f32 v8, v8, v8
v_lshlrev_b32 v8, 16, v8
v_mul_f32 v8, 0x3db504f3, v8
v_cvt_pk_bf16_f32 v8, v8, v8
v_lshlrev_b32 v8, 16, v8
v_cvt_pk_bf16_f32 v9, v9, v9
v_lshlrev_b32 v9, 16, v9
v_mul_f32 v9, 0x3db504f3, v9
v_cvt_pk_bf16_f32 v9, v9, v9
v_lshlrev_b32 v9, 16, v9
v_cvt_pk_bf16_f32 v10, v10, v10
v_lshlrev_b32 v10, 16, v10
v_mul_f32 v10, 0x3db504f3, v10
v_cvt_pk_bf16_f32 v10, v10, v10
v_lshlrev_b32 v10, 16, v10
v_cvt_pk_bf16_f32 v11, v11, v11
v_lshlrev_b32 v11, 16, v11
v_mul_f32 v11, 0x3db504f3, v11
v_cvt_pk_bf16_f32 v11, v11, v11
v_lshlrev_b32 v11, 16, v11
v_cvt_pk_bf16_f32 v12, v12, v12
v_lshlrev_b32 v12, 16, v12
v_mul_f32 v12, 0x3db504f3, v12
v_cvt_pk_bf16_f32 v12, v12, v12
v_lshlrev_b32 v12, 16, v12
v_cvt_pk_bf16_f32 v13, v13, v13
v_lshlrev_b32 v13, 16, v13
v_mul_f32 v13, 0x3db504f3, v13
v_cvt_pk_bf16_f32 v13, v13, v13
v_lshlrev_b32 v13, 16, v13
v_cvt_pk_bf16_f32 v14, v14, v14
v_lshlrev_b32 v14, 16, v14
v_mul_f32 v14, 0x3db504f3, v14
v_cvt_pk_bf16_f32 v14, v14, v14
v_lshlrev_b32 v14, 16, v14
v_cvt_pk_bf16_f32 v15, v15, v15
v_lshlrev_b32 v15, 16, v15
v_mul_f32 v15, 0x3db504f3, v15
v_cvt_pk_bf16_f32 v15, v15, v15
v_lshlrev_b32 v15, 16, v15
v_cvt_pk_bf16_f32 v16, v16, v16
v_lshlrev_b32 v16, 16, v16
v_mul_f32 v16, 0x3db504f3, v16
v_cvt_pk_bf16_f32 v16, v16, v16
v_lshlrev_b32 v16, 16, v16
v_cvt_pk_bf16_f32 v17, v17, v17
v_lshlrev_b32 v17, 16, v17
v_mul_f32 v17, 0x3db504f3, v17
v_cvt_pk_bf16_f32 v17, v17, v17
v_lshlrev_b32 v17, 16, v17
v_cvt_pk_bf16_f32 v18, v18, v18
v_lshlrev_b32 v18, 16, v18
v_mul_f32 v18, 0x3db504f3, v18
v_cvt_pk_bf16_f32 v18, v18, v18
v_lshlrev_b32 v18, 16, v18
v_cvt_pk_bf16_f32 v19, v19, v19
v_lshlrev_b32 v19, 16, v19
v_mul_f32 v19, 0x3db504f3, v19
v_cvt_pk_bf16_f32 v19, v19, v19
v_lshlrev_b32 v19, 16, v19
v_cvt_pk_bf16_f32 v20, v20, v20
v_lshlrev_b32 v20, 16, v20
v_mul_f32 v20, 0x3db504f3, v20
v_cvt_pk_bf16_f32 v20, v20, v20
v_lshlrev_b32 v20, 16, v20
v_cvt_pk_bf16_f32 v21, v21, v21
v_lshlrev_b32 v21, 16, v21
v_mul_f32 v21, 0x3db504f3, v21
v_cvt_pk_bf16_f32 v21, v21, v21
v_lshlrev_b32 v21, 16, v21
v_cvt_pk_bf16_f32 v22, v22, v22
v_lshlrev_b32 v22, 16, v22
v_mul_f32 v22, 0x3db504f3, v22
v_cvt_pk_bf16_f32 v22, v22, v22
v_lshlrev_b32 v22, 16, v22
v_cvt_pk_bf16_f32 v23, v23, v23
v_lshlrev_b32 v23, 16, v23
v_mul_f32 v23, 0x3db504f3, v23
v_cvt_pk_bf16_f32 v23, v23, v23
v_lshlrev_b32 v23, 16, v23
v_cvt_pk_bf16_f32 v24, v24, v24
v_lshlrev_b32 v24, 16, v24
v_mul_f32 v24, 0x3db504f3, v24
v_cvt_pk_bf16_f32 v24, v24, v24
v_lshlrev_b32 v24, 16, v24
v_cvt_pk_bf16_f32 v25, v25, v25
v_lshlrev_b32 v25, 16, v25
v_mul_f32 v25, 0x3db504f3, v25
v_cvt_pk_bf16_f32 v25, v25, v25
v_lshlrev_b32 v25, 16, v25
v_cvt_pk_bf16_f32 v26, v26, v26
v_lshlrev_b32 v26, 16, v26
v_mul_f32 v26, 0x3db504f3, v26
v_cvt_pk_bf16_f32 v26, v26, v26
v_lshlrev_b32 v26, 16, v26
v_cvt_pk_bf16_f32 v27, v27, v27
v_lshlrev_b32 v27, 16, v27
v_mul_f32 v27, 0x3db504f3, v27
v_cvt_pk_bf16_f32 v27, v27, v27
v_lshlrev_b32 v27, 16, v27
v_add_u32 v60, 0, v61
v_cmp_gt_u32 vcc, v60, v62
s_nop 1
v_cndmask_b32 v8, v8, v59, vcc
v_add_u32 v60, 1, v61
v_cmp_gt_u32 vcc, v60, v62
s_nop 1
v_cndmask_b32 v9, v9, v59, vcc
v_add_u32 v60, 2, v61
v_cmp_gt_u32 vcc, v60, v62
s_nop 1
v_cndmask_b32 v10, v10, v59, vcc
v_add_u32 v60, 3, v61
v_cmp_gt_u32 vcc, v60, v62
s_nop 1
v_cndmask_b32 v11, v11, v59, vcc
v_add_u32 v60, 0, v61
v_cmp_gt_u32 vcc, v60, v57
s_nop 1
v_cndmask_b32 v12, v12, v59, vcc
v_add_u32 v60, 1, v61
v_cmp_gt_u32 vcc, v60, v57
s_nop 1
v_cndmask_b32 v13, v13, v59, vcc
v_add_u32 v60, 2, v61
v_cmp_gt_u32 vcc, v60, v57
s_nop 1
v_cndmask_b32 v14, v14, v59, vcc
v_add_u32 v60, 3, v61
v_cmp_gt_u32 vcc, v60, v57
s_nop 1
v_cndmask_b32 v15, v15, v59, vcc
v_add_u32 v60, 0, v61
v_cmp_gt_u32 vcc, v60, v62
s_nop 1
v_cndmask_b32 v20, v20, v59, vcc
v_add_u32 v60, 1, v61
v_cmp_gt_u32 vcc, v60, v62
s_nop 1
v_cndmask_b32 v21, v21, v59, vcc
v_add_u32 v60, 2, v61
v_cmp_gt_u32 vcc, v60, v62
s_nop 1
v_cndmask_b32 v22, v22, v59, vcc
v_add_u32 v60, 3, v61
v_cmp_gt_u32 vcc, v60, v62
s_nop 1
v_cndmask_b32 v23, v23, v59, vcc
v_add_u32 v60, 0, v61
v_cmp_gt_u32 vcc, v60, v57
s_nop 1
v_cndmask_b32 v24, v24, v59, vcc
v_add_u32 v60, 1, v61
v_cmp_gt_u32 vcc, v60, v57
s_nop 1
v_cndmask_b32 v25, v25, v59, vcc
v_add_u32 v60, 2, v61
v_cmp_gt_u32 vcc, v60, v57
s_nop 1
v_cndmask_b32 v26, v26, v59, vcc
v_add_u32 v60, 3, v61
v_cmp_gt_u32 vcc, v60, v57
s_nop 1
v_cndmask_b32 v27, v27, v59, vcc
v_max_f32 v28, v8, v9
v_max_f32 v28, v28, v10
v_max_f32 v28, v28, v11
v_max_f32 v28, v28, v12
v_max_f32 v28, v28, v13
v_max_f32 v28, v28, v14
v_max_f32 v28, v28, v15
v_xor_b32 v29, 64, v63
ds_bpermute_b32 v30, v29, v28
s_waitcnt lgkmcnt(0)
v_max_f32 v28, v28, v30
v_xor_b32 v29, 128, v63
ds_bpermute_b32 v30, v29, v28
s_waitcnt lgkmcnt(0)
v_max_f32 v28, v28, v30
v_mov_b32 v31, 0
v_sub_f32 v8, v8, v28
v_mul_f32 v8, 0x3fb8aa3b, v8
v_exp_f32 v8, v8
s_nop 0
v_add_f32 v31, v31, v8
v_sub_f32 v9, v9, v28
v_mul_f32 v9, 0x3fb8aa3b, v9
v_exp_f32 v9, v9
s_nop 0
v_add_f32 v31, v31, v9
v_sub_f32 v10, v10, v28
v_mul_f32 v10, 0x3fb8aa3b, v10
v_exp_f32 v10, v10
s_nop 0
v_add_f32 v31, v31, v10
v_sub_f32 v11, v11, v28
v_mul_f32 v11, 0x3fb8aa3b, v11
v_exp_f32 v11, v11
s_nop 0
v_add_f32 v31, v31, v11
v_sub_f32 v12, v12, v28
v_mul_f32 v12, 0x3fb8aa3b, v12
v_exp_f32 v12, v12
s_nop 0
v_add_f32 v31, v31, v12
v_sub_f32 v13, v13, v28
v_mul_f32 v13, 0x3fb8aa3b, v13
v_exp_f32 v13, v13
s_nop 0
v_add_f32 v31, v31, v13
v_sub_f32 v14, v14, v28
v_mul_f32 v14, 0x3fb8aa3b, v14
v_exp_f32 v14, v14
s_nop 0
v_add_f32 v31, v31, v14
v_sub_f32 v15, v15, v28
v_mul_f32 v15, 0x3fb8aa3b, v15
v_exp_f32 v15, v15
s_nop 0
v_add_f32 v31, v31, v15
v_xor_b32 v29, 64, v63
ds_bpermute_b32 v30, v29, v31
s_waitcnt lgkmcnt(0)
v_add_f32 v31, v31, v30
v_xor_b32 v29, 128, v63
ds_bpermute_b32 v30, v29, v31
s_waitcnt lgkmcnt(0)
v_add_f32 v31, v31, v30
v_rcp_f32 v31, v31
s_nop 0
v_mul_f32 v8, v8, v31
v_mul_f32 v9, v9, v31
v_mul_f32 v10, v10, v31
v_mul_f32 v11, v11, v31
v_mul_f32 v12, v12, v31
v_mul_f32 v13, v13, v31
v_mul_f32 v14, v14, v31
v_mul_f32 v15, v15, v31
v_cvt_pk_bf16_f32 v8, v8, v9
v_cvt_pk_bf16_f32 v9, v10, v11
v_cvt_pk_bf16_f32 v12, v12, v13
v_cvt_pk_bf16_f32 v13, v14, v15
v_max_f32 v28, v16, v17
v_max_f32 v28, v28, v18
v_max_f32 v28, v28, v19
v_max_f32 v28, v28, v20
v_max_f32 v28, v28, v21
v_max_f32 v28, v28, v22
v_max_f32 v28, v28, v23
v_max_f32 v28, v28, v24
v_max_f32 v28, v28, v25
v_max_f32 v28, v28, v26
v_max_f32 v28, v28, v27
v_xor_b32 v29, 64, v63
ds_bpermute_b32 v30, v29, v28
s_waitcnt lgkmcnt(0)
v_max_f32 v28, v28, v30
v_xor_b32 v29, 128, v63
ds_bpermute_b32 v30, v29, v28
s_waitcnt lgkmcnt(0)
v_max_f32 v28, v28, v30
v_mov_b32 v31, 0
v_sub_f32 v16, v16, v28
v_mul_f32 v16, 0x3fb8aa3b, v16
v_exp_f32 v16, v16
s_nop 0
v_add_f32 v31, v31, v16
v_sub_f32 v17, v17, v28
v_mul_f32 v17, 0x3fb8aa3b, v17
v_exp_f32 v17, v17
s_nop 0
v_add_f32 v31, v31, v17
v_sub_f32 v18, v18, v28
v_mul_f32 v18, 0x3fb8aa3b, v18
v_exp_f32 v18, v18
s_nop 0
v_add_f32 v31, v31, v18
v_sub_f32 v19, v19, v28
v_mul_f32 v19, 0x3fb8aa3b, v19
v_exp_f32 v19, v19
s_nop 0
v_add_f32 v31, v31, v19
v_sub_f32 v20, v20, v28
v_mul_f32 v20, 0x3fb8aa3b, v20
v_exp_f32 v20, v20
s_nop 0
v_add_f32 v31, v31, v20
v_sub_f32 v21, v21, v28
v_mul_f32 v21, 0x3fb8aa3b, v21
v_exp_f32 v21, v21
s_nop 0
v_add_f32 v31, v31, v21
v_sub_f32 v22, v22, v28
v_mul_f32 v22, 0x3fb8aa3b, v22
v_exp_f32 v22, v22
s_nop 0
v_add_f32 v31, v31, v22
v_sub_f32 v23, v23, v28
v_mul_f32 v23, 0x3fb8aa3b, v23
v_exp_f32 v23, v23
s_nop 0
v_add_f32 v31, v31, v23
v_sub_f32 v24, v24, v28
v_mul_f32 v24, 0x3fb8aa3b, v24
v_exp_f32 v24, v24
s_nop 0
v_add_f32 v31, v31, v24
v_sub_f32 v25, v25, v28
v_mul_f32 v25, 0x3fb8aa3b, v25
v_exp_f32 v25, v25
s_nop 0
v_add_f32 v31, v31, v25
v_sub_f32 v26, v26, v28
v_mul_f32 v26, 0x3fb8aa3b, v26
v_exp_f32 v26, v26
s_nop 0
v_add_f32 v31, v31, v26
v_sub_f32 v27, v27, v28
v_mul_f32 v27, 0x3fb8aa3b, v27
v_exp_f32 v27, v27
s_nop 0
v_add_f32 v31, v31, v27
v_xor_b32 v29, 64, v63
ds_bpermute_b32 v30, v29, v31
s_waitcnt lgkmcnt(0)
v_add_f32 v31, v31, v30
v_xor_b32 v29, 128, v63
ds_bpermute_b32 v30, v29, v31
s_waitcnt lgkmcnt(0)
v_add_f32 v31, v31, v30
v_rcp_f32 v31, v31
s_nop 0
v_mul_f32 v16, v16, v31
v_mul_f32 v17, v17, v31
v_mul_f32 v18, v18, v31
v_mul_f32 v19, v19, v31
v_mul_f32 v20, v20, v31
v_mul_f32 v21, v21, v31
v_mul_f32 v22, v22, v31
v_mul_f32 v23, v23, v31
v_mul_f32 v24, v24, v31
v_mul_f32 v25, v25, v31
v_mul_f32 v26, v26, v31
v_mul_f32 v27, v27, v31
v_cvt_pk_bf16_f32 v16, v16, v17
v_cvt_pk_bf16_f32 v17, v18, v19
v_cvt_pk_bf16_f32 v20, v20, v21
v_cvt_pk_bf16_f32 v21, v22, v23
v_cvt_pk_bf16_f32 v24, v24, v25
v_cvt_pk_bf16_f32 v25, v26, v27
s_waitcnt vmcnt(0)
v_lshlrev_b32 v2, 13, v62
v_lshl_add_u32 v2, v58, 3, v2
s_add_u32 s16, s7, 83886080
s_add_u32 s17, s16, 131072
v_mov_b32 v32, 0
v_mov_b32 v33, 0
v_mov_b32 v34, 0
v_mov_b32 v35, 0
v_mov_b32 v36, 0
v_mov_b32 v37, 0
v_mov_b32 v38, 0
v_mov_b32 v39, 0
s_nop 1
v_mfma_f32_16x16x16_bf16 v[32:35], v[144:145], v[8:9], v[32:35]
v_mfma_f32_16x16x16_bf16 v[32:35], v[148:149], v[12:13], v[32:35]
v_mfma_f32_16x16x16_bf16 v[36:39], v[144:145], v[16:17], v[36:39]
v_mfma_f32_16x16x16_bf16 v[36:39], v[146:147], v[20:21], v[36:39]
v_mfma_f32_16x16x16_bf16 v[36:39], v[148:149], v[24:25], v[36:39]
s_nop 15
v_cvt_pk_bf16_f32 v32, v32, v33
v_cvt_pk_bf16_f32 v33, v34, v35
v_cvt_pk_bf16_f32 v36, v36, v37
v_cvt_pk_bf16_f32 v37, v38, v39
buffer_store_dwordx2 v[32:33], v2, s[8:11], s16 offen offset:0
buffer_store_dwordx2 v[36:37], v2, s[8:11], s17 offen offset:0
s_nop 1
v_mov_b32 v32, 0
v_mov_b32 v33, 0
v_mov_b32 v34, 0
v_mov_b32 v35, 0
v_mov_b32 v36, 0
v_mov_b32 v37, 0
v_mov_b32 v38, 0
v_mov_b32 v39, 0
s_nop 1
v_mfma_f32_16x16x16_bf16 v[32:35], v[150:151], v[8:9], v[32:35]
v_mfma_f32_16x16x16_bf16 v[32:35], v[154:155], v[12:13], v[32:35]
v_mfma_f32_16x16x16_bf16 v[36:39], v[150:151], v[16:17], v[36:39]
v_mfma_f32_16x16x16_bf16 v[36:39], v[152:153], v[20:21], v[36:39]
v_mfma_f32_16x16x16_bf16 v[36:39], v[154:155], v[24:25], v[36:39]
s_nop 15
v_cvt_pk_bf16_f32 v32, v32, v33
v_cvt_pk_bf16_f32 v33, v34, v35
v_cvt_pk_bf16_f32 v36, v36, v37
v_cvt_pk_bf16_f32 v37, v38, v39
buffer_store_dwordx2 v[32:33], v2, s[8:11], s16 offen offset:32
buffer_store_dwordx2 v[36:37], v2, s[8:11], s17 offen offset:32
s_nop 1
v_mov_b32 v32, 0
v_mov_b32 v33, 0
v_mov_b32 v34, 0
v_mov_b32 v35, 0
v_mov_b32 v36, 0
v_mov_b32 v37, 0
v_mov_b32 v38, 0
v_mov_b32 v39, 0
s_nop 1
v_mfma_f32_16x16x16_bf16 v[32:35], v[156:157], v[8:9], v[32:35]
v_mfma_f32_16x16x16_bf16 v[32:35], v[160:161], v[12:13], v[32:35]
v_mfma_f32_16x16x16_bf16 v[36:39], v[156:157], v[16:17], v[36:39]
v_mfma_f32_16x16x16_bf16 v[36:39], v[158:159], v[20:21], v[36:39]
v_mfma_f32_16x16x16_bf16 v[36:39], v[160:161], v[24:25], v[36:39]
s_nop 15
v_cvt_pk_bf16_f32 v32, v32, v33
v_cvt_pk_bf16_f32 v33, v34, v35
v_cvt_pk_bf16_f32 v36, v36, v37
v_cvt_pk_bf16_f32 v37, v38, v39
buffer_store_dwordx2 v[32:33], v2, s[8:11], s16 offen offset:64
buffer_store_dwordx2 v[36:37], v2, s[8:11], s17 offen offset:64
s_nop 1
v_mov_b32 v32, 0
v_mov_b32 v33, 0
v_mov_b32 v34, 0
v_mov_b32 v35, 0
v_mov_b32 v36, 0
v_mov_b32 v37, 0
v_mov_b32 v38, 0
v_mov_b32 v39, 0
s_nop 1
v_mfma_f32_16x16x16_bf16 v[32:35], v[162:163], v[8:9], v[32:35]
v_mfma_f32_16x16x16_bf16 v[32:35], v[166:167], v[12:13], v[32:35]
v_mfma_f32_16x16x16_bf16 v[36:39], v[162:163], v[16:17], v[36:39]
v_mfma_f32_16x16x16_bf16 v[36:39], v[164:165], v[20:21], v[36:39]
v_mfma_f32_16x16x16_bf16 v[36:39], v[166:167], v[24:25], v[36:39]
s_nop 15
v_cvt_pk_bf16_f32 v32, v32, v33
v_cvt_pk_bf16_f32 v33, v34, v35
v_cvt_pk_bf16_f32 v36, v36, v37
v_cvt_pk_bf16_f32 v37, v38, v39
buffer_store_dwordx2 v[32:33], v2, s[8:11], s16 offen offset:96
buffer_store_dwordx2 v[36:37], v2, s[8:11], s17 offen offset:96
s_nop 1
v_mov_b32 v32, 0
v_mov_b32 v33, 0
v_mov_b32 v34, 0
v_mov_b32 v35, 0
v_mov_b32 v36, 0
v_mov_b32 v37, 0
v_mov_b32 v38, 0
v_mov_b32 v39, 0
s_nop 1
v_mfma_f32_16x16x16_bf16 v[32:35], v[168:169], v[8:9], v[32:35]
v_mfma_f32_16x16x16_bf16 v[32:35], v[172:173], v[12:13], v[32:35]
v_mfma_f32_16x16x16_bf16 v[36:39], v[168:169], v[16:17], v[36:39]
v_mfma_f32_16x16x16_bf16 v[36:39], v[170:171], v[20:21], v[36:39]
v_mfma_f32_16x16x16_bf16 v[36:39], v[172:173], v[24:25], v[36:39]
s_nop 15
v_cvt_pk_bf16_f32 v32, v32, v33
v_cvt_pk_bf16_f32 v33, v34, v35
v_cvt_pk_bf16_f32 v36, v36, v37
v_cvt_pk_bf16_f32 v37, v38, v39
buffer_store_dwordx2 v[32:33], v2, s[8:11], s16 offen offset:128
buffer_store_dwordx2 v[36:37], v2, s[8:11], s17 offen offset:128
s_nop 1
v_mov_b32 v32, 0
v_mov_b32 v33, 0
v_mov_b32 v34, 0
v_mov_b32 v35, 0
v_mov_b32 v36, 0
v_mov_b32 v37, 0
v_mov_b32 v38, 0
v_mov_b32 v39, 0
s_nop 1
v_mfma_f32_16x16x16_bf16 v[32:35], v[174:175], v[8:9], v[32:35]
v_mfma_f32_16x16x16_bf16 v[32:35], v[178:179], v[12:13], v[32:35]
v_mfma_f32_16x16x16_bf16 v[36:39], v[174:175], v[16:17], v[36:39]
v_mfma_f32_16x16x16_bf16 v[36:39], v[176:177], v[20:21], v[36:39]
v_mfma_f32_16x16x16_bf16 v[36:39], v[178:179], v[24:25], v[36:39]
s_nop 15
v_cvt_pk_bf16_f32 v32, v32, v33
v_cvt_pk_bf16_f32 v33, v34, v35
v_cvt_pk_bf16_f32 v36, v36, v37
v_cvt_pk_bf16_f32 v37, v38, v39
buffer_store_dwordx2 v[32:33], v2, s[8:11], s16 offen offset:160
buffer_store_dwordx2 v[36:37], v2, s[8:11], s17 offen offset:160
s_nop 1
v_mov_b32 v32, 0
v_mov_b32 v33, 0
v_mov_b32 v34, 0
v_mov_b32 v35, 0
v_mov_b32 v36, 0
v_mov_b32 v37, 0
v_mov_b32 v38, 0
v_mov_b32 v39, 0
s_nop 1
v_mfma_f32_16x16x16_bf16 v[32:35], v[180:181], v[8:9], v[32:35]
v_mfma_f32_16x16x16_bf16 v[32:35], v[184:185], v[12:13], v[32:35]
v_mfma_f32_16x16x16_bf16 v[36:39], v[180:181], v[16:17], v[36:39]
v_mfma_f32_16x16x16_bf16 v[36:39], v[182:183], v[20:21], v[36:39]
v_mfma_f32_16x16x16_bf16 v[36:39], v[184:185], v[24:25], v[36:39]
s_nop 15
v_cvt_pk_bf16_f32 v32, v32, v33
v_cvt_pk_bf16_f32 v33, v34, v35
v_cvt_pk_bf16_f32 v36, v36, v37
v_cvt_pk_bf16_f32 v37, v38, v39
buffer_store_dwordx2 v[32:33], v2, s[8:11], s16 offen offset:192
buffer_store_dwordx2 v[36:37], v2, s[8:11], s17 offen offset:192
s_nop 1
v_mov_b32 v32, 0
v_mov_b32 v33, 0
v_mov_b32 v34, 0
v_mov_b32 v35, 0
v_mov_b32 v36, 0
v_mov_b32 v37, 0
v_mov_b32 v38, 0
v_mov_b32 v39, 0
s_nop 1
v_mfma_f32_16x16x16_bf16 v[32:35], v[186:187], v[8:9], v[32:35]
v_mfma_f32_16x16x16_bf16 v[32:35], v[190:191], v[12:13], v[32:35]
v_mfma_f32_16x16x16_bf16 v[36:39], v[186:187], v[16:17], v[36:39]
v_mfma_f32_16x16x16_bf16 v[36:39], v[188:189], v[20:21], v[36:39]
v_mfma_f32_16x16x16_bf16 v[36:39], v[190:191], v[24:25], v[36:39]
s_nop 15
v_cvt_pk_bf16_f32 v32, v32, v33
v_cvt_pk_bf16_f32 v33, v34, v35
v_cvt_pk_bf16_f32 v36, v36, v37
v_cvt_pk_bf16_f32 v37, v38, v39
buffer_store_dwordx2 v[32:33], v2, s[8:11], s16 offen offset:224
buffer_store_dwordx2 v[36:37], v2, s[8:11], s17 offen offset:224
s_nop 1
Lend_attn:
s_endpgm
.p2align 8
.globl wo_kernel
.type wo_kernel,@function
wo_kernel:
s_load_dwordx2 s[8:9], s[0:1], 112
s_waitcnt lgkmcnt(0)
s_mov_b32 s10, 268435456
s_mov_b32 s11, 0x00020000
s_mov_b32 s4, 64
s_cmp_ge_u32 s2, s4
s_cbranch_scc1 Lend_wo_kernel
s_and_b32 s5, s2, 15
s_lshr_b32 s6, s2, 4
v_lshrrev_b32 v2, 6, v0
s_nop 0
v_readfirstlane_b32 s3, v2
v_and_b32 v1, 63, v0
s_lshr_b32 s7, s3, 1
s_lshl_b32 s7, s7, 6
s_lshl_b32 s20, s5, 7
s_add_u32 s20, s20, s7
s_and_b32 s7, s3, 1
s_lshl_b32 s7, s7, 2
s_lshl_b32 s21, s6, 3
s_add_u32 s21, s21, s7
v_and_b32 v96, 15, v1
v_lshrrev_b32 v97, 4, v1
v_add_u32 v98, s20, v96
v_mul_u32_u24 v98, 8192, v98
v_lshl_add_u32 v98, v97, 4, v98
v_lshlrev_b32 v99, 4, v1
s_load_dwordx2 s[12:13], s[0:1], 96
s_waitcnt lgkmcnt(0)
s_mov_b32 s14, 2097152
s_mov_b32 s15, 0x00020000
s_load_dwordx2 s[16:17], s[0:1], 0
s_waitcnt lgkmcnt(0)
s_mov_b32 s18, 2097152
s_mov_b32 s19, 0x00020000
s_mov_b32 s27, 0
v_add_u32 v100, 83886080, v98
v_add_u32 v101, 84017152, v98
v_add_u32 v102, 84148224, v98
v_add_u32 v103, 84279296, v98
s_add_u32 s22, s21, 0
s_mul_i32 s22, s22, 131072
s_add_u32 s22, s22, 16777216
v_add_u32 v104, s22, v99
s_add_u32 s22, s21, 1
s_mul_i32 s22, s22, 131072
s_add_u32 s22, s22, 16777216
v_add_u32 v105, s22, v99
s_add_u32 s22, s21, 2
s_mul_i32 s22, s22, 131072
s_add_u32 s22, s22, 16777216
v_add_u32 v106, s22, v99
s_add_u32 s22, s21, 3
s_mul_i32 s22, s22, 131072
s_add_u32 s22, s22, 16777216
v_add_u32 v107, s22, v99
v_mov_b32 v0, 0
v_mov_b32 v1, 0
v_mov_b32 v2, 0
v_mov_b32 v3, 0
v_mov_b32 v4, 0
v_mov_b32 v5, 0
v_mov_b32 v6, 0
v_mov_b32 v7, 0
v_mov_b32 v8, 0
v_mov_b32 v9, 0
v_mov_b32 v10, 0
v_mov_b32 v11, 0
v_mov_b32 v12, 0
v_mov_b32 v13, 0
v_mov_b32 v14, 0
v_mov_b32 v15, 0
v_mov_b32 v16, 0
v_mov_b32 v17, 0
v_mov_b32 v18, 0
v_mov_b32 v19, 0
v_mov_b32 v20, 0
v_mov_b32 v21, 0
v_mov_b32 v22, 0
v_mov_b32 v23, 0
v_mov_b32 v24, 0
v_mov_b32 v25, 0
v_mov_b32 v26, 0
v_mov_b32 v27, 0
v_mov_b32 v28, 0
v_mov_b32 v29, 0
v_mov_b32 v30, 0
v_mov_b32 v31, 0
v_mov_b32 v32, 0
v_mov_b32 v33, 0
v_mov_b32 v34, 0
v_mov_b32 v35, 0
v_mov_b32 v36, 0
v_mov_b32 v37, 0
v_mov_b32 v38, 0
v_mov_b32 v39, 0
v_mov_b32 v40, 0
v_mov_b32 v41, 0
v_mov_b32 v42, 0
v_mov_b32 v43, 0
v_mov_b32 v44, 0
v_mov_b32 v45, 0
v_mov_b32 v46, 0
v_mov_b32 v47, 0
v_mov_b32 v48, 0
v_mov_b32 v49, 0
v_mov_b32 v50, 0
v_mov_b32 v51, 0
v_mov_b32 v52, 0
v_mov_b32 v53, 0
v_mov_b32 v54, 0
v_mov_b32 v55, 0
v_mov_b32 v56, 0
v_mov_b32 v57, 0
v_mov_b32 v58, 0
v_mov_b32 v59, 0
v_mov_b32 v60, 0
v_mov_b32 v61, 0
v_mov_b32 v62, 0
v_mov_b32 v63, 0
s_mov_b32 s24, 0
s_mov_b32 s25, 0
s_mov_b32 s26, 64
buffer_load_dwordx4 v[108:111], v100, s[8:11], s24 offen
buffer_load_dwordx4 v[112:115], v101, s[8:11], s24 offen
buffer_load_dwordx4 v[116:119], v102, s[8:11], s24 offen
buffer_load_dwordx4 v[120:123], v103, s[8:11], s24 offen
buffer_load_dwordx4 v[124:127], v104, s[8:11], s25 offen
buffer_load_dwordx4 v[128:131], v105, s[8:11], s25 offen
buffer_load_dwordx4 v[132:135], v106, s[8:11], s25 offen
buffer_load_dwordx4 v[136:139], v107, s[8:11], s25 offen
s_add_u32 s24, s24, 64
s_add_u32 s25, s25, 1024
Lw:
buffer_load_dwordx4 v[140:143], v100, s[8:11], s24 offen
buffer_load_dwordx4 v[144:147], v101, s[8:11], s24 offen
buffer_load_dwordx4 v[148:151], v102, s[8:11], s24 offen
buffer_load_dwordx4 v[152:155], v103, s[8:11], s24 offen
buffer_load_dwordx4 v[156:159], v104, s[8:11], s25 offen
buffer_load_dwordx4 v[160:163], v105, s[8:11], s25 offen
buffer_load_dwordx4 v[164:167], v106, s[8:11], s25 offen
buffer_load_dwordx4 v[168:171], v107, s[8:11], s25 offen
s_add_u32 s24, s24, 64
s_add_u32 s25, s25, 1024
s_waitcnt vmcnt(8)
v_mfma_f32_16x16x32_bf16 v[0:3], v[124:127], v[108:111], v[0:3]
v_mfma_f32_16x16x32_bf16 v[4:7], v[128:131], v[108:111], v[4:7]
v_mfma_f32_16x16x32_bf16 v[8:11], v[132:135], v[108:111], v[8:11]
v_mfma_f32_16x16x32_bf16 v[12:15], v[136:139], v[108:111], v[12:15]
v_mfma_f32_16x16x32_bf16 v[16:19], v[124:127], v[112:115], v[16:19]
v_mfma_f32_16x16x32_bf16 v[20:23], v[128:131], v[112:115], v[20:23]
v_mfma_f32_16x16x32_bf16 v[24:27], v[132:135], v[112:115], v[24:27]
v_mfma_f32_16x16x32_bf16 v[28:31], v[136:139], v[112:115], v[28:31]
v_mfma_f32_16x16x32_bf16 v[32:35], v[124:127], v[116:119], v[32:35]
v_mfma_f32_16x16x32_bf16 v[36:39], v[128:131], v[116:119], v[36:39]
v_mfma_f32_16x16x32_bf16 v[40:43], v[132:135], v[116:119], v[40:43]
v_mfma_f32_16x16x32_bf16 v[44:47], v[136:139], v[116:119], v[44:47]
v_mfma_f32_16x16x32_bf16 v[48:51], v[124:127], v[120:123], v[48:51]
v_mfma_f32_16x16x32_bf16 v[52:55], v[128:131], v[120:123], v[52:55]
v_mfma_f32_16x16x32_bf16 v[56:59], v[132:135], v[120:123], v[56:59]
v_mfma_f32_16x16x32_bf16 v[60:63], v[136:139], v[120:123], v[60:63]
buffer_load_dwordx4 v[108:111], v100, s[8:11], s24 offen
buffer_load_dwordx4 v[112:115], v101, s[8:11], s24 offen
buffer_load_dwordx4 v[116:119], v102, s[8:11], s24 offen
buffer_load_dwordx4 v[120:123], v103, s[8:11], s24 offen
buffer_load_dwordx4 v[124:127], v104, s[8:11], s25 offen
buffer_load_dwordx4 v[128:131], v105, s[8:11], s25 offen
buffer_load_dwordx4 v[132:135], v106, s[8:11], s25 offen
buffer_load_dwordx4 v[136:139], v107, s[8:11], s25 offen
s_add_u32 s24, s24, 64
s_add_u32 s25, s25, 1024
s_waitcnt vmcnt(8)
v_mfma_f32_16x16x32_bf16 v[0:3], v[156:159], v[140:143], v[0:3]
v_mfma_f32_16x16x32_bf16 v[4:7], v[160:163], v[140:143], v[4:7]
v_mfma_f32_16x16x32_bf16 v[8:11], v[164:167], v[140:143], v[8:11]
v_mfma_f32_16x16x32_bf16 v[12:15], v[168:171], v[140:143], v[12:15]
v_mfma_f32_16x16x32_bf16 v[16:19], v[156:159], v[144:147], v[16:19]
v_mfma_f32_16x16x32_bf16 v[20:23], v[160:163], v[144:147], v[20:23]
v_mfma_f32_16x16x32_bf16 v[24:27], v[164:167], v[144:147], v[24:27]
v_mfma_f32_16x16x32_bf16 v[28:31], v[168:171], v[144:147], v[28:31]
v_mfma_f32_16x16x32_bf16 v[32:35], v[156:159], v[148:151], v[32:35]
v_mfma_f32_16x16x32_bf16 v[36:39], v[160:163], v[148:151], v[36:39]
v_mfma_f32_16x16x32_bf16 v[40:43], v[164:167], v[148:151], v[40:43]
v_mfma_f32_16x16x32_bf16 v[44:47], v[168:171], v[148:151], v[44:47]
v_mfma_f32_16x16x32_bf16 v[48:51], v[156:159], v[152:155], v[48:51]
v_mfma_f32_16x16x32_bf16 v[52:55], v[160:163], v[152:155], v[52:55]
v_mfma_f32_16x16x32_bf16 v[56:59], v[164:167], v[152:155], v[56:59]
v_mfma_f32_16x16x32_bf16 v[60:63], v[168:171], v[152:155], v[60:63]
s_sub_u32 s26, s26, 1
s_cmp_lg_u32 s26, 0
s_cbranch_scc1 Lw
s_waitcnt vmcnt(0)
s_nop 15
v_add_u32 v94, s20, v96
v_mul_u32_u24 v94, 1024, v94
v_lshl_add_u32 v94, v97, 3, v94
s_add_u32 s22, s21, 0
s_lshl_b32 s22, s22, 5
s_add_u32 s28, s22, 0
s_add_u32 s29, s28, 109051904
buffer_load_dwordx2 v[84:85], v94, s[16:19], s28 offen
buffer_load_dwordx2 v[92:93], v94, s[8:11], s29 offen
s_waitcnt vmcnt(0)
v_lshlrev_b32 v86, 16, v84
v_and_b32 v87, 0xffff0000, v84
v_lshlrev_b32 v88, 16, v85
v_and_b32 v89, 0xffff0000, v85
v_lshlrev_b32 v80, 16, v92
v_and_b32 v81, 0xffff0000, v92
v_lshlrev_b32 v82, 16, v93
v_and_b32 v83, 0xffff0000, v93
v_cvt_pk_bf16_f32 v0, v0, v0
v_lshlrev_b32 v0, 16, v0
v_mul_f32 v0, v0, v80
v_cvt_pk_bf16_f32 v0, v0, v0
v_lshlrev_b32 v0, 16, v0
v_add_f32 v0, v0, v86
v_cvt_pk_bf16_f32 v1, v1, v1
v_lshlrev_b32 v1, 16, v1
v_mul_f32 v1, v1, v81
v_cvt_pk_bf16_f32 v1, v1, v1
v_lshlrev_b32 v1, 16, v1
v_add_f32 v1, v1, v87
v_cvt_pk_bf16_f32 v2, v2, v2
v_lshlrev_b32 v2, 16, v2
v_mul_f32 v2, v2, v82
v_cvt_pk_bf16_f32 v2, v2, v2
v_lshlrev_b32 v2, 16, v2
v_add_f32 v2, v2, v88
v_cvt_pk_bf16_f32 v3, v3, v3
v_lshlrev_b32 v3, 16, v3
v_mul_f32 v3, v3, v83
v_cvt_pk_bf16_f32 v3, v3, v3
v_lshlrev_b32 v3, 16, v3
v_add_f32 v3, v3, v89
v_cvt_pk_bf16_f32 v0, v0, v1
v_cvt_pk_bf16_f32 v1, v2, v3
s_add_u32 s28, s22, 16384
s_add_u32 s29, s28, 109051904
buffer_load_dwordx2 v[84:85], v94, s[16:19], s28 offen
buffer_load_dwordx2 v[92:93], v94, s[8:11], s29 offen
s_waitcnt vmcnt(0)
v_lshlrev_b32 v86, 16, v84
v_and_b32 v87, 0xffff0000, v84
v_lshlrev_b32 v88, 16, v85
v_and_b32 v89, 0xffff0000, v85
v_lshlrev_b32 v80, 16, v92
v_and_b32 v81, 0xffff0000, v92
v_lshlrev_b32 v82, 16, v93
v_and_b32 v83, 0xffff0000, v93
v_cvt_pk_bf16_f32 v16, v16, v16
v_lshlrev_b32 v16, 16, v16
v_mul_f32 v16, v16, v80
v_cvt_pk_bf16_f32 v16, v16, v16
v_lshlrev_b32 v16, 16, v16
v_add_f32 v16, v16, v86
v_cvt_pk_bf16_f32 v17, v17, v17
v_lshlrev_b32 v17, 16, v17
v_mul_f32 v17, v17, v81
v_cvt_pk_bf16_f32 v17, v17, v17
v_lshlrev_b32 v17, 16, v17
v_add_f32 v17, v17, v87
v_cvt_pk_bf16_f32 v18, v18, v18
v_lshlrev_b32 v18, 16, v18
v_mul_f32 v18, v18, v82
v_cvt_pk_bf16_f32 v18, v18, v18
v_lshlrev_b32 v18, 16, v18
v_add_f32 v18, v18, v88
v_cvt_pk_bf16_f32 v19, v19, v19
v_lshlrev_b32 v19, 16, v19
v_mul_f32 v19, v19, v83
v_cvt_pk_bf16_f32 v19, v19, v19
v_lshlrev_b32 v19, 16, v19
v_add_f32 v19, v19, v89
v_cvt_pk_bf16_f32 v16, v16, v17
v_cvt_pk_bf16_f32 v17, v18, v19
s_add_u32 s28, s22, 32768
s_add_u32 s29, s28, 109051904
buffer_load_dwordx2 v[84:85], v94, s[16:19], s28 offen
buffer_load_dwordx2 v[92:93], v94, s[8:11], s29 offen
s_waitcnt vmcnt(0)
v_lshlrev_b32 v86, 16, v84
v_and_b32 v87, 0xffff0000, v84
v_lshlrev_b32 v88, 16, v85
v_and_b32 v89, 0xffff0000, v85
v_lshlrev_b32 v80, 16, v92
v_and_b32 v81, 0xffff0000, v92
v_lshlrev_b32 v82, 16, v93
v_and_b32 v83, 0xffff0000, v93
v_cvt_pk_bf16_f32 v32, v32, v32
v_lshlrev_b32 v32, 16, v32
v_mul_f32 v32, v32, v80
v_cvt_pk_bf16_f32 v32, v32, v32
v_lshlrev_b32 v32, 16, v32
v_add_f32 v32, v32, v86
v_cvt_pk_bf16_f32 v33, v33, v33
v_lshlrev_b32 v33, 16, v33
v_mul_f32 v33, v33, v81
v_cvt_pk_bf16_f32 v33, v33, v33
v_lshlrev_b32 v33, 16, v33
v_add_f32 v33, v33, v87
v_cvt_pk_bf16_f32 v34, v34, v34
v_lshlrev_b32 v34, 16, v34
v_mul_f32 v34, v34, v82
v_cvt_pk_bf16_f32 v34, v34, v34
v_lshlrev_b32 v34, 16, v34
v_add_f32 v34, v34, v88
v_cvt_pk_bf16_f32 v35, v35, v35
v_lshlrev_b32 v35, 16, v35
v_mul_f32 v35, v35, v83
v_cvt_pk_bf16_f32 v35, v35, v35
v_lshlrev_b32 v35, 16, v35
v_add_f32 v35, v35, v89
v_cvt_pk_bf16_f32 v32, v32, v33
v_cvt_pk_bf16_f32 v33, v34, v35
s_add_u32 s28, s22, 49152
s_add_u32 s29, s28, 109051904
buffer_load_dwordx2 v[84:85], v94, s[16:19], s28 offen
buffer_load_dwordx2 v[92:93], v94, s[8:11], s29 offen
s_waitcnt vmcnt(0)
v_lshlrev_b32 v86, 16, v84
v_and_b32 v87, 0xffff0000, v84
v_lshlrev_b32 v88, 16, v85
v_and_b32 v89, 0xffff0000, v85
v_lshlrev_b32 v80, 16, v92
v_and_b32 v81, 0xffff0000, v92
v_lshlrev_b32 v82, 16, v93
v_and_b32 v83, 0xffff0000, v93
v_cvt_pk_bf16_f32 v48, v48, v48
v_lshlrev_b32 v48, 16, v48
v_mul_f32 v48, v48, v80
v_cvt_pk_bf16_f32 v48, v48, v48
v_lshlrev_b32 v48, 16, v48
v_add_f32 v48, v48, v86
v_cvt_pk_bf16_f32 v49, v49, v49
v_lshlrev_b32 v49, 16, v49
v_mul_f32 v49, v49, v81
v_cvt_pk_bf16_f32 v49, v49, v49
v_lshlrev_b32 v49, 16, v49
v_add_f32 v49, v49, v87
v_cvt_pk_bf16_f32 v50, v50, v50
v_lshlrev_b32 v50, 16, v50
v_mul_f32 v50, v50, v82
v_cvt_pk_bf16_f32 v50, v50, v50
v_lshlrev_b32 v50, 16, v50
v_add_f32 v50, v50, v88
v_cvt_pk_bf16_f32 v51, v51, v51
v_lshlrev_b32 v51, 16, v51
v_mul_f32 v51, v51, v83
v_cvt_pk_bf16_f32 v51, v51, v51
v_lshlrev_b32 v51, 16, v51
v_add_f32 v51, v51, v89
v_cvt_pk_bf16_f32 v48, v48, v49
v_cvt_pk_bf16_f32 v49, v50, v51
s_add_u32 s23, s22, s27
buffer_store_dwordx2 v[0:1], v94, s[12:15], s23 offen
s_add_u32 s23, s23, 16384
buffer_store_dwordx2 v[16:17], v94, s[12:15], s23 offen
s_add_u32 s23, s23, 16384
buffer_store_dwordx2 v[32:33], v94, s[12:15], s23 offen
s_add_u32 s23, s23, 16384
buffer_store_dwordx2 v[48:49], v94, s[12:15], s23 offen
s_add_u32 s23, s23, 16384
s_add_u32 s22, s21, 1
s_lshl_b32 s22, s22, 5
s_add_u32 s28, s22, 0
s_add_u32 s29, s28, 109051904
buffer_load_dwordx2 v[84:85], v94, s[16:19], s28 offen
buffer_load_dwordx2 v[92:93], v94, s[8:11], s29 offen
s_waitcnt vmcnt(0)
v_lshlrev_b32 v86, 16, v84
v_and_b32 v87, 0xffff0000, v84
v_lshlrev_b32 v88, 16, v85
v_and_b32 v89, 0xffff0000, v85
v_lshlrev_b32 v80, 16, v92
v_and_b32 v81, 0xffff0000, v92
v_lshlrev_b32 v82, 16, v93
v_and_b32 v83, 0xffff0000, v93
v_cvt_pk_bf16_f32 v4, v4, v4
v_lshlrev_b32 v4, 16, v4
v_mul_f32 v4, v4, v80
v_cvt_pk_bf16_f32 v4, v4, v4
v_lshlrev_b32 v4, 16, v4
v_add_f32 v4, v4, v86
v_cvt_pk_bf16_f32 v5, v5, v5
v_lshlrev_b32 v5, 16, v5
v_mul_f32 v5, v5, v81
v_cvt_pk_bf16_f32 v5, v5, v5
v_lshlrev_b32 v5, 16, v5
v_add_f32 v5, v5, v87
v_cvt_pk_bf16_f32 v6, v6, v6
v_lshlrev_b32 v6, 16, v6
v_mul_f32 v6, v6, v82
v_cvt_pk_bf16_f32 v6, v6, v6
v_lshlrev_b32 v6, 16, v6
v_add_f32 v6, v6, v88
v_cvt_pk_bf16_f32 v7, v7, v7
v_lshlrev_b32 v7, 16, v7
v_mul_f32 v7, v7, v83
v_cvt_pk_bf16_f32 v7, v7, v7
v_lshlrev_b32 v7, 16, v7
v_add_f32 v7, v7, v89
v_cvt_pk_bf16_f32 v4, v4, v5
v_cvt_pk_bf16_f32 v5, v6, v7
s_add_u32 s28, s22, 16384
s_add_u32 s29, s28, 109051904
buffer_load_dwordx2 v[84:85], v94, s[16:19], s28 offen
buffer_load_dwordx2 v[92:93], v94, s[8:11], s29 offen
s_waitcnt vmcnt(0)
v_lshlrev_b32 v86, 16, v84
v_and_b32 v87, 0xffff0000, v84
v_lshlrev_b32 v88, 16, v85
v_and_b32 v89, 0xffff0000, v85
v_lshlrev_b32 v80, 16, v92
v_and_b32 v81, 0xffff0000, v92
v_lshlrev_b32 v82, 16, v93
v_and_b32 v83, 0xffff0000, v93
v_cvt_pk_bf16_f32 v20, v20, v20
v_lshlrev_b32 v20, 16, v20
v_mul_f32 v20, v20, v80
v_cvt_pk_bf16_f32 v20, v20, v20
v_lshlrev_b32 v20, 16, v20
v_add_f32 v20, v20, v86
v_cvt_pk_bf16_f32 v21, v21, v21
v_lshlrev_b32 v21, 16, v21
v_mul_f32 v21, v21, v81
v_cvt_pk_bf16_f32 v21, v21, v21
v_lshlrev_b32 v21, 16, v21
v_add_f32 v21, v21, v87
v_cvt_pk_bf16_f32 v22, v22, v22
v_lshlrev_b32 v22, 16, v22
v_mul_f32 v22, v22, v82
v_cvt_pk_bf16_f32 v22, v22, v22
v_lshlrev_b32 v22, 16, v22
v_add_f32 v22, v22, v88
v_cvt_pk_bf16_f32 v23, v23, v23
v_lshlrev_b32 v23, 16, v23
v_mul_f32 v23, v23, v83
v_cvt_pk_bf16_f32 v23, v23, v23
v_lshlrev_b32 v23, 16, v23
v_add_f32 v23, v23, v89
v_cvt_pk_bf16_f32 v20, v20, v21
v_cvt_pk_bf16_f32 v21, v22, v23
s_add_u32 s28, s22, 32768
s_add_u32 s29, s28, 109051904
buffer_load_dwordx2 v[84:85], v94, s[16:19], s28 offen
buffer_load_dwordx2 v[92:93], v94, s[8:11], s29 offen
s_waitcnt vmcnt(0)
v_lshlrev_b32 v86, 16, v84
v_and_b32 v87, 0xffff0000, v84
v_lshlrev_b32 v88, 16, v85
v_and_b32 v89, 0xffff0000, v85
v_lshlrev_b32 v80, 16, v92
v_and_b32 v81, 0xffff0000, v92
v_lshlrev_b32 v82, 16, v93
v_and_b32 v83, 0xffff0000, v93
v_cvt_pk_bf16_f32 v36, v36, v36
v_lshlrev_b32 v36, 16, v36
v_mul_f32 v36, v36, v80
v_cvt_pk_bf16_f32 v36, v36, v36
v_lshlrev_b32 v36, 16, v36
v_add_f32 v36, v36, v86
v_cvt_pk_bf16_f32 v37, v37, v37
v_lshlrev_b32 v37, 16, v37
v_mul_f32 v37, v37, v81
v_cvt_pk_bf16_f32 v37, v37, v37
v_lshlrev_b32 v37, 16, v37
v_add_f32 v37, v37, v87
v_cvt_pk_bf16_f32 v38, v38, v38
v_lshlrev_b32 v38, 16, v38
v_mul_f32 v38, v38, v82
v_cvt_pk_bf16_f32 v38, v38, v38
v_lshlrev_b32 v38, 16, v38
v_add_f32 v38, v38, v88
v_cvt_pk_bf16_f32 v39, v39, v39
v_lshlrev_b32 v39, 16, v39
v_mul_f32 v39, v39, v83
v_cvt_pk_bf16_f32 v39, v39, v39
v_lshlrev_b32 v39, 16, v39
v_add_f32 v39, v39, v89
v_cvt_pk_bf16_f32 v36, v36, v37
v_cvt_pk_bf16_f32 v37, v38, v39
s_add_u32 s28, s22, 49152
s_add_u32 s29, s28, 109051904
buffer_load_dwordx2 v[84:85], v94, s[16:19], s28 offen
buffer_load_dwordx2 v[92:93], v94, s[8:11], s29 offen
s_waitcnt vmcnt(0)
v_lshlrev_b32 v86, 16, v84
v_and_b32 v87, 0xffff0000, v84
v_lshlrev_b32 v88, 16, v85
v_and_b32 v89, 0xffff0000, v85
v_lshlrev_b32 v80, 16, v92
v_and_b32 v81, 0xffff0000, v92
v_lshlrev_b32 v82, 16, v93
v_and_b32 v83, 0xffff0000, v93
v_cvt_pk_bf16_f32 v52, v52, v52
v_lshlrev_b32 v52, 16, v52
v_mul_f32 v52, v52, v80
v_cvt_pk_bf16_f32 v52, v52, v52
v_lshlrev_b32 v52, 16, v52
v_add_f32 v52, v52, v86
v_cvt_pk_bf16_f32 v53, v53, v53
v_lshlrev_b32 v53, 16, v53
v_mul_f32 v53, v53, v81
v_cvt_pk_bf16_f32 v53, v53, v53
v_lshlrev_b32 v53, 16, v53
v_add_f32 v53, v53, v87
v_cvt_pk_bf16_f32 v54, v54, v54
v_lshlrev_b32 v54, 16, v54
v_mul_f32 v54, v54, v82
v_cvt_pk_bf16_f32 v54, v54, v54
v_lshlrev_b32 v54, 16, v54
v_add_f32 v54, v54, v88
v_cvt_pk_bf16_f32 v55, v55, v55
v_lshlrev_b32 v55, 16, v55
v_mul_f32 v55, v55, v83
v_cvt_pk_bf16_f32 v55, v55, v55
v_lshlrev_b32 v55, 16, v55
v_add_f32 v55, v55, v89
v_cvt_pk_bf16_f32 v52, v52, v53
v_cvt_pk_bf16_f32 v53, v54, v55
s_add_u32 s23, s22, s27
buffer_store_dwordx2 v[4:5], v94, s[12:15], s23 offen
s_add_u32 s23, s23, 16384
buffer_store_dwordx2 v[20:21], v94, s[12:15], s23 offen
s_add_u32 s23, s23, 16384
buffer_store_dwordx2 v[36:37], v94, s[12:15], s23 offen
s_add_u32 s23, s23, 16384
buffer_store_dwordx2 v[52:53], v94, s[12:15], s23 offen
s_add_u32 s23, s23, 16384
s_add_u32 s22, s21, 2
s_lshl_b32 s22, s22, 5
s_add_u32 s28, s22, 0
s_add_u32 s29, s28, 109051904
buffer_load_dwordx2 v[84:85], v94, s[16:19], s28 offen
buffer_load_dwordx2 v[92:93], v94, s[8:11], s29 offen
s_waitcnt vmcnt(0)
v_lshlrev_b32 v86, 16, v84
v_and_b32 v87, 0xffff0000, v84
v_lshlrev_b32 v88, 16, v85
v_and_b32 v89, 0xffff0000, v85
v_lshlrev_b32 v80, 16, v92
v_and_b32 v81, 0xffff0000, v92
v_lshlrev_b32 v82, 16, v93
v_and_b32 v83, 0xffff0000, v93
v_cvt_pk_bf16_f32 v8, v8, v8
v_lshlrev_b32 v8, 16, v8
v_mul_f32 v8, v8, v80
v_cvt_pk_bf16_f32 v8, v8, v8
v_lshlrev_b32 v8, 16, v8
v_add_f32 v8, v8, v86
v_cvt_pk_bf16_f32 v9, v9, v9
v_lshlrev_b32 v9, 16, v9
v_mul_f32 v9, v9, v81
v_cvt_pk_bf16_f32 v9, v9, v9
v_lshlrev_b32 v9, 16, v9
v_add_f32 v9, v9, v87
v_cvt_pk_bf16_f32 v10, v10, v10
v_lshlrev_b32 v10, 16, v10
v_mul_f32 v10, v10, v82
v_cvt_pk_bf16_f32 v10, v10, v10
v_lshlrev_b32 v10, 16, v10
v_add_f32 v10, v10, v88
v_cvt_pk_bf16_f32 v11, v11, v11
v_lshlrev_b32 v11, 16, v11
v_mul_f32 v11, v11, v83
v_cvt_pk_bf16_f32 v11, v11, v11
v_lshlrev_b32 v11, 16, v11
v_add_f32 v11, v11, v89
v_cvt_pk_bf16_f32 v8, v8, v9
v_cvt_pk_bf16_f32 v9, v10, v11
s_add_u32 s28, s22, 16384
s_add_u32 s29, s28, 109051904
buffer_load_dwordx2 v[84:85], v94, s[16:19], s28 offen
buffer_load_dwordx2 v[92:93], v94, s[8:11], s29 offen
s_waitcnt vmcnt(0)
v_lshlrev_b32 v86, 16, v84
v_and_b32 v87, 0xffff0000, v84
v_lshlrev_b32 v88, 16, v85
v_and_b32 v89, 0xffff0000, v85
v_lshlrev_b32 v80, 16, v92
v_and_b32 v81, 0xffff0000, v92
v_lshlrev_b32 v82, 16, v93
v_and_b32 v83, 0xffff0000, v93
v_cvt_pk_bf16_f32 v24, v24, v24
v_lshlrev_b32 v24, 16, v24
v_mul_f32 v24, v24, v80
v_cvt_pk_bf16_f32 v24, v24, v24
v_lshlrev_b32 v24, 16, v24
v_add_f32 v24, v24, v86
v_cvt_pk_bf16_f32 v25, v25, v25
v_lshlrev_b32 v25, 16, v25
v_mul_f32 v25, v25, v81
v_cvt_pk_bf16_f32 v25, v25, v25
v_lshlrev_b32 v25, 16, v25
v_add_f32 v25, v25, v87
v_cvt_pk_bf16_f32 v26, v26, v26
v_lshlrev_b32 v26, 16, v26
v_mul_f32 v26, v26, v82
v_cvt_pk_bf16_f32 v26, v26, v26
v_lshlrev_b32 v26, 16, v26
v_add_f32 v26, v26, v88
v_cvt_pk_bf16_f32 v27, v27, v27
v_lshlrev_b32 v27, 16, v27
v_mul_f32 v27, v27, v83
v_cvt_pk_bf16_f32 v27, v27, v27
v_lshlrev_b32 v27, 16, v27
v_add_f32 v27, v27, v89
v_cvt_pk_bf16_f32 v24, v24, v25
v_cvt_pk_bf16_f32 v25, v26, v27
s_add_u32 s28, s22, 32768
s_add_u32 s29, s28, 109051904
buffer_load_dwordx2 v[84:85], v94, s[16:19], s28 offen
buffer_load_dwordx2 v[92:93], v94, s[8:11], s29 offen
s_waitcnt vmcnt(0)
v_lshlrev_b32 v86, 16, v84
v_and_b32 v87, 0xffff0000, v84
v_lshlrev_b32 v88, 16, v85
v_and_b32 v89, 0xffff0000, v85
v_lshlrev_b32 v80, 16, v92
v_and_b32 v81, 0xffff0000, v92
v_lshlrev_b32 v82, 16, v93
v_and_b32 v83, 0xffff0000, v93
v_cvt_pk_bf16_f32 v40, v40, v40
v_lshlrev_b32 v40, 16, v40
v_mul_f32 v40, v40, v80
v_cvt_pk_bf16_f32 v40, v40, v40
v_lshlrev_b32 v40, 16, v40
v_add_f32 v40, v40, v86
v_cvt_pk_bf16_f32 v41, v41, v41
v_lshlrev_b32 v41, 16, v41
v_mul_f32 v41, v41, v81
v_cvt_pk_bf16_f32 v41, v41, v41
v_lshlrev_b32 v41, 16, v41
v_add_f32 v41, v41, v87
v_cvt_pk_bf16_f32 v42, v42, v42
v_lshlrev_b32 v42, 16, v42
v_mul_f32 v42, v42, v82
v_cvt_pk_bf16_f32 v42, v42, v42
v_lshlrev_b32 v42, 16, v42
v_add_f32 v42, v42, v88
v_cvt_pk_bf16_f32 v43, v43, v43
v_lshlrev_b32 v43, 16, v43
v_mul_f32 v43, v43, v83
v_cvt_pk_bf16_f32 v43, v43, v43
v_lshlrev_b32 v43, 16, v43
v_add_f32 v43, v43, v89
v_cvt_pk_bf16_f32 v40, v40, v41
v_cvt_pk_bf16_f32 v41, v42, v43
s_add_u32 s28, s22, 49152
s_add_u32 s29, s28, 109051904
buffer_load_dwordx2 v[84:85], v94, s[16:19], s28 offen
buffer_load_dwordx2 v[92:93], v94, s[8:11], s29 offen
s_waitcnt vmcnt(0)
v_lshlrev_b32 v86, 16, v84
v_and_b32 v87, 0xffff0000, v84
v_lshlrev_b32 v88, 16, v85
v_and_b32 v89, 0xffff0000, v85
v_lshlrev_b32 v80, 16, v92
v_and_b32 v81, 0xffff0000, v92
v_lshlrev_b32 v82, 16, v93
v_and_b32 v83, 0xffff0000, v93
v_cvt_pk_bf16_f32 v56, v56, v56
v_lshlrev_b32 v56, 16, v56
v_mul_f32 v56, v56, v80
v_cvt_pk_bf16_f32 v56, v56, v56
v_lshlrev_b32 v56, 16, v56
v_add_f32 v56, v56, v86
v_cvt_pk_bf16_f32 v57, v57, v57
v_lshlrev_b32 v57, 16, v57
v_mul_f32 v57, v57, v81
v_cvt_pk_bf16_f32 v57, v57, v57
v_lshlrev_b32 v57, 16, v57
v_add_f32 v57, v57, v87
v_cvt_pk_bf16_f32 v58, v58, v58
v_lshlrev_b32 v58, 16, v58
v_mul_f32 v58, v58, v82
v_cvt_pk_bf16_f32 v58, v58, v58
v_lshlrev_b32 v58, 16, v58
v_add_f32 v58, v58, v88
v_cvt_pk_bf16_f32 v59, v59, v59
v_lshlrev_b32 v59, 16, v59
v_mul_f32 v59, v59, v83
v_cvt_pk_bf16_f32 v59, v59, v59
v_lshlrev_b32 v59, 16, v59
v_add_f32 v59, v59, v89
v_cvt_pk_bf16_f32 v56, v56, v57
v_cvt_pk_bf16_f32 v57, v58, v59
s_add_u32 s23, s22, s27
buffer_store_dwordx2 v[8:9], v94, s[12:15], s23 offen
s_add_u32 s23, s23, 16384
buffer_store_dwordx2 v[24:25], v94, s[12:15], s23 offen
s_add_u32 s23, s23, 16384
buffer_store_dwordx2 v[40:41], v94, s[12:15], s23 offen
s_add_u32 s23, s23, 16384
buffer_store_dwordx2 v[56:57], v94, s[12:15], s23 offen
s_add_u32 s23, s23, 16384
s_add_u32 s22, s21, 3
s_lshl_b32 s22, s22, 5
s_add_u32 s28, s22, 0
s_add_u32 s29, s28, 109051904
buffer_load_dwordx2 v[84:85], v94, s[16:19], s28 offen
buffer_load_dwordx2 v[92:93], v94, s[8:11], s29 offen
s_waitcnt vmcnt(0)
v_lshlrev_b32 v86, 16, v84
v_and_b32 v87, 0xffff0000, v84
v_lshlrev_b32 v88, 16, v85
v_and_b32 v89, 0xffff0000, v85
v_lshlrev_b32 v80, 16, v92
v_and_b32 v81, 0xffff0000, v92
v_lshlrev_b32 v82, 16, v93
v_and_b32 v83, 0xffff0000, v93
v_cvt_pk_bf16_f32 v12, v12, v12
v_lshlrev_b32 v12, 16, v12
v_mul_f32 v12, v12, v80
v_cvt_pk_bf16_f32 v12, v12, v12
v_lshlrev_b32 v12, 16, v12
v_add_f32 v12, v12, v86
v_cvt_pk_bf16_f32 v13, v13, v13
v_lshlrev_b32 v13, 16, v13
v_mul_f32 v13, v13, v81
v_cvt_pk_bf16_f32 v13, v13, v13
v_lshlrev_b32 v13, 16, v13
v_add_f32 v13, v13, v87
v_cvt_pk_bf16_f32 v14, v14, v14
v_lshlrev_b32 v14, 16, v14
v_mul_f32 v14, v14, v82
v_cvt_pk_bf16_f32 v14, v14, v14
v_lshlrev_b32 v14, 16, v14
v_add_f32 v14, v14, v88
v_cvt_pk_bf16_f32 v15, v15, v15
v_lshlrev_b32 v15, 16, v15
v_mul_f32 v15, v15, v83
v_cvt_pk_bf16_f32 v15, v15, v15
v_lshlrev_b32 v15, 16, v15
v_add_f32 v15, v15, v89
v_cvt_pk_bf16_f32 v12, v12, v13
v_cvt_pk_bf16_f32 v13, v14, v15
s_add_u32 s28, s22, 16384
s_add_u32 s29, s28, 109051904
buffer_load_dwordx2 v[84:85], v94, s[16:19], s28 offen
buffer_load_dwordx2 v[92:93], v94, s[8:11], s29 offen
s_waitcnt vmcnt(0)
v_lshlrev_b32 v86, 16, v84
v_and_b32 v87, 0xffff0000, v84
v_lshlrev_b32 v88, 16, v85
v_and_b32 v89, 0xffff0000, v85
v_lshlrev_b32 v80, 16, v92
v_and_b32 v81, 0xffff0000, v92
v_lshlrev_b32 v82, 16, v93
v_and_b32 v83, 0xffff0000, v93
v_cvt_pk_bf16_f32 v28, v28, v28
v_lshlrev_b32 v28, 16, v28
v_mul_f32 v28, v28, v80
v_cvt_pk_bf16_f32 v28, v28, v28
v_lshlrev_b32 v28, 16, v28
v_add_f32 v28, v28, v86
v_cvt_pk_bf16_f32 v29, v29, v29
v_lshlrev_b32 v29, 16, v29
v_mul_f32 v29, v29, v81
v_cvt_pk_bf16_f32 v29, v29, v29
v_lshlrev_b32 v29, 16, v29
v_add_f32 v29, v29, v87
v_cvt_pk_bf16_f32 v30, v30, v30
v_lshlrev_b32 v30, 16, v30
v_mul_f32 v30, v30, v82
v_cvt_pk_bf16_f32 v30, v30, v30
v_lshlrev_b32 v30, 16, v30
v_add_f32 v30, v30, v88
v_cvt_pk_bf16_f32 v31, v31, v31
v_lshlrev_b32 v31, 16, v31
v_mul_f32 v31, v31, v83
v_cvt_pk_bf16_f32 v31, v31, v31
v_lshlrev_b32 v31, 16, v31
v_add_f32 v31, v31, v89
v_cvt_pk_bf16_f32 v28, v28, v29
v_cvt_pk_bf16_f32 v29, v30, v31
s_add_u32 s28, s22, 32768
s_add_u32 s29, s28, 109051904
buffer_load_dwordx2 v[84:85], v94, s[16:19], s28 offen
buffer_load_dwordx2 v[92:93], v94, s[8:11], s29 offen
s_waitcnt vmcnt(0)
v_lshlrev_b32 v86, 16, v84
v_and_b32 v87, 0xffff0000, v84
v_lshlrev_b32 v88, 16, v85
v_and_b32 v89, 0xffff0000, v85
v_lshlrev_b32 v80, 16, v92
v_and_b32 v81, 0xffff0000, v92
v_lshlrev_b32 v82, 16, v93
v_and_b32 v83, 0xffff0000, v93
v_cvt_pk_bf16_f32 v44, v44, v44
v_lshlrev_b32 v44, 16, v44
v_mul_f32 v44, v44, v80
v_cvt_pk_bf16_f32 v44, v44, v44
v_lshlrev_b32 v44, 16, v44
v_add_f32 v44, v44, v86
v_cvt_pk_bf16_f32 v45, v45, v45
v_lshlrev_b32 v45, 16, v45
v_mul_f32 v45, v45, v81
v_cvt_pk_bf16_f32 v45, v45, v45
v_lshlrev_b32 v45, 16, v45
v_add_f32 v45, v45, v87
v_cvt_pk_bf16_f32 v46, v46, v46
v_lshlrev_b32 v46, 16, v46
v_mul_f32 v46, v46, v82
v_cvt_pk_bf16_f32 v46, v46, v46
v_lshlrev_b32 v46, 16, v46
v_add_f32 v46, v46, v88
v_cvt_pk_bf16_f32 v47, v47, v47
v_lshlrev_b32 v47, 16, v47
v_mul_f32 v47, v47, v83
v_cvt_pk_bf16_f32 v47, v47, v47
v_lshlrev_b32 v47, 16, v47
v_add_f32 v47, v47, v89
v_cvt_pk_bf16_f32 v44, v44, v45
v_cvt_pk_bf16_f32 v45, v46, v47
s_add_u32 s28, s22, 49152
s_add_u32 s29, s28, 109051904
buffer_load_dwordx2 v[84:85], v94, s[16:19], s28 offen
buffer_load_dwordx2 v[92:93], v94, s[8:11], s29 offen
s_waitcnt vmcnt(0)
v_lshlrev_b32 v86, 16, v84
v_and_b32 v87, 0xffff0000, v84
v_lshlrev_b32 v88, 16, v85
v_and_b32 v89, 0xffff0000, v85
v_lshlrev_b32 v80, 16, v92
v_and_b32 v81, 0xffff0000, v92
v_lshlrev_b32 v82, 16, v93
v_and_b32 v83, 0xffff0000, v93
v_cvt_pk_bf16_f32 v60, v60, v60
v_lshlrev_b32 v60, 16, v60
v_mul_f32 v60, v60, v80
v_cvt_pk_bf16_f32 v60, v60, v60
v_lshlrev_b32 v60, 16, v60
v_add_f32 v60, v60, v86
v_cvt_pk_bf16_f32 v61, v61, v61
v_lshlrev_b32 v61, 16, v61
v_mul_f32 v61, v61, v81
v_cvt_pk_bf16_f32 v61, v61, v61
v_lshlrev_b32 v61, 16, v61
v_add_f32 v61, v61, v87
v_cvt_pk_bf16_f32 v62, v62, v62
v_lshlrev_b32 v62, 16, v62
v_mul_f32 v62, v62, v82
v_cvt_pk_bf16_f32 v62, v62, v62
v_lshlrev_b32 v62, 16, v62
v_add_f32 v62, v62, v88
v_cvt_pk_bf16_f32 v63, v63, v63
v_lshlrev_b32 v63, 16, v63
v_mul_f32 v63, v63, v83
v_cvt_pk_bf16_f32 v63, v63, v63
v_lshlrev_b32 v63, 16, v63
v_add_f32 v63, v63, v89
v_cvt_pk_bf16_f32 v60, v60, v61
v_cvt_pk_bf16_f32 v61, v62, v63
s_add_u32 s23, s22, s27
buffer_store_dwordx2 v[12:13], v94, s[12:15], s23 offen
s_add_u32 s23, s23, 16384
buffer_store_dwordx2 v[28:29], v94, s[12:15], s23 offen
s_add_u32 s23, s23, 16384
buffer_store_dwordx2 v[44:45], v94, s[12:15], s23 offen
s_add_u32 s23, s23, 16384
buffer_store_dwordx2 v[60:61], v94, s[12:15], s23 offen
s_add_u32 s23, s23, 16384
Lend_wo_kernel:
s_endpgm
.section .rodata,"a"
.p2align 6
.amdhsa_kernel prep_kernel
  .amdhsa_next_free_vgpr 64
  .amdhsa_next_free_sgpr 102
  .amdhsa_accum_offset 64
  .amdhsa_group_segment_fixed_size 0
  .amdhsa_kernarg_size 120
  .amdhsa_user_sgpr_count 2
  .amdhsa_user_sgpr_kernarg_segment_ptr 1
  .amdhsa_system_sgpr_workgroup_id_x 1
.end_amdhsa_kernel
.p2align 6
.amdhsa_kernel qkv_kernel
  .amdhsa_next_free_vgpr 176
  .amdhsa_next_free_sgpr 102
  .amdhsa_accum_offset 176
  .amdhsa_group_segment_fixed_size 0
  .amdhsa_kernarg_size 120
  .amdhsa_user_sgpr_count 2
  .amdhsa_user_sgpr_kernarg_segment_ptr 1
  .amdhsa_system_sgpr_workgroup_id_x 1
.end_amdhsa_kernel
.p2align 6
.amdhsa_kernel mlp1_kernel
  .amdhsa_next_free_vgpr 176
  .amdhsa_next_free_sgpr 102
  .amdhsa_accum_offset 176
  .amdhsa_group_segment_fixed_size 0
  .amdhsa_kernarg_size 120
  .amdhsa_user_sgpr_count 2
  .amdhsa_user_sgpr_kernarg_segment_ptr 1
  .amdhsa_system_sgpr_workgroup_id_x 1
.end_amdhsa_kernel
.p2align 6
.amdhsa_kernel mlp2_kernel
  .amdhsa_next_free_vgpr 176
  .amdhsa_next_free_sgpr 102
  .amdhsa_accum_offset 176
  .amdhsa_group_segment_fixed_size 0
  .amdhsa_kernarg_size 120
  .amdhsa_user_sgpr_count 2
  .amdhsa_user_sgpr_kernarg_segment_ptr 1
  .amdhsa_system_sgpr_workgroup_id_x 1
.end_amdhsa_kernel
.p2align 6
.amdhsa_kernel chain_kernel
  .amdhsa_next_free_vgpr 512
  .amdhsa_next_free_sgpr 102
  .amdhsa_accum_offset 256
  .amdhsa_group_segment_fixed_size 0
  .amdhsa_kernarg_size 120
  .amdhsa_user_sgpr_count 2
  .amdhsa_user_sgpr_kernarg_segment_ptr 1
  .amdhsa_system_sgpr_workgroup_id_x 1
.end_amdhsa_kernel
.p2align 6
.amdhsa_kernel attn_kernel
  .amdhsa_next_free_vgpr 200
  .amdhsa_next_free_sgpr 102
  .amdhsa_accum_offset 200
  .amdhsa_group_segment_fixed_size 0
  .amdhsa_kernarg_size 120
  .amdhsa_user_sgpr_count 2
  .amdhsa_user_sgpr_kernarg_segment_ptr 1
  .amdhsa_system_sgpr_workgroup_id_x 1
.end_amdhsa_kernel
.p2align 6
.amdhsa_kernel wo_kernel
  .amdhsa_next_free_vgpr 176
  .amdhsa_next_free_sgpr 102
  .amdhsa_accum_offset 176
  .amdhsa_group_segment_fixed_size 0
  .amdhsa_kernarg_size 120
  .amdhsa_user_sgpr_count 2
  .amdhsa_user_sgpr_kernarg_segment_ptr 1
  .amdhsa_system_sgpr_workgroup_id_x 1
.end_amdhsa_kernel
```
